```python
import torch

def _softmax(x, axis=-1):
    return torch.softmax(x, dim=axis)
def _gelu(x):
    return torch.nn.functional.gelu(x, approximate="tanh")
def _silu(x):
    return torch.nn.functional.silu(x)
def _sigmoid(x):
    return torch.sigmoid(x)
def _layernorm(x, axis=-1, eps=1e-5):
    m = x.mean(dim=axis, keepdim=True)
    v = x.var(dim=axis, keepdim=True, unbiased=False)
    return (x - m) / torch.sqrt(v + eps)
def _scatter_add(tgt, idx, src, axis=0):
    return tgt.clone().index_add_(axis, idx, src)
def _segment_sum(src, seg, n):
    out = torch.zeros((n,) + src.shape[1:], dtype=src.dtype)
    return out.index_add_(0, seg, src)
def _pad(x, pw):
    flat = tuple(v for pair in reversed(pw) for v in pair)
    return torch.nn.functional.pad(x, flat)

kernel_name = 'sequential_preLN__mha_block__dense_activation_relu__prompt'

def setup_inputs():

    _w = (lambda a: (lambda t: t.to(torch.bfloat16) if t.is_floating_point() else t)(torch.as_tensor(a)))
    def _A_setup():
        B, S, D, H = 1, 2048, 512, 32
        return {
            "x": _w((lambda *s: torch.randn(*s, dtype=torch.bfloat16) * 0.05)(B, S, D)),
            "wqkv": _w((lambda *s: torch.randn(*s, dtype=torch.bfloat16) * 0.05)(D, 3 * D)),
            "wo": _w((lambda *s: torch.randn(*s, dtype=torch.bfloat16) * 0.05)(D, D)),
        }
    _A_in = _A_setup()

    def _B_setup():
        B, S, D, Dff = 1, 2048, 512, 1792
        return {
            "x": _w((lambda *s: torch.randn(*s, dtype=torch.bfloat16) * 0.05)(B, S, D)),
            "w1": _w((lambda *s: torch.randn(*s, dtype=torch.bfloat16) * 0.05)(D, Dff)),
            "w2": _w((lambda *s: torch.randn(*s, dtype=torch.bfloat16) * 0.05)(Dff, D)),
        }
    _B_in = _B_setup()

    return {
        "A_x": _A_in["x"],
        "A_wqkv": _A_in["wqkv"],
        "A_wo": _A_in["wo"],
        "B_x": _B_in["x"],
        "B_w1": _B_in["w1"],
        "B_w2": _B_in["w2"],
    }

def reference(A_x, A_wqkv, A_wo, B_x, B_w1, B_w2):
    def _A_ref(x, wqkv, wo):
        B, S, D = x.shape
        H = 32
        Dh = D // H
        qkv = (lambda x, *d: x.permute(*d))((x @ wqkv).reshape(B, S, 3, H, Dh), 2, 0, 3, 1, 4)
        q, k, v = qkv[0], qkv[1], qkv[2]
        scores = torch.einsum("bhqd,bhkd->bhqk", q, k) * (Dh ** -0.5)
        p = _softmax(scores, axis=-1)
        o = torch.einsum("bhqk,bhkd->bhqd", p, v)
        return (lambda x, *d: x.permute(*d))(o, 0, 2, 1, 3).reshape(B, S, D) @ wo

    def _B_ref(x, w1, w2):
        h = torch.einsum("bsd,df->bsf", x, w1)
        zero = torch.zeros_like(h)
        h = torch.maximum(h, zero)
        return torch.einsum("bsf,fd->bsd", h, w2)

    x = A_x
    h = x + _A_ref(_layernorm(x, axis=-1), A_wqkv, A_wo)
    h2 = h + _B_ref(_layernorm(h, axis=-1), B_w1, B_w2)
    return h2
```

```asm
; @launch grid=(256,1,1) block=(512,1,1) lds=163840
.amdgcn_target "amdgcn-amd-amdhsa--gfx950"
.text
.globl sequential_preLN__mha_block__dense_activation_relu__prompt_kernel
.p2align 8
.type sequential_preLN__mha_block__dense_activation_relu__prompt_kernel,@function
sequential_preLN__mha_block__dense_activation_relu__prompt_kernel:
    s_cmp_ge_u32 s2, 256
    s_cbranch_scc1 L_end
    s_load_dwordx16 s[4:19], s[0:1], 0
    s_load_dwordx2 s[20:21], s[0:1], 64
    v_and_b32 v10, 63, v0
    v_lshrrev_b32 v11, 6, v0
    v_lshlrev_b32 v1, 4, v10
    v_readfirstlane_b32 s22, v11
    s_bfe_u32 s60, s2, 0x10002
    s_lshl_b32 s60, s60, 4
    s_bfe_u32 s48, s2, 0x40003
    s_add_u32 s60, s60, s48
    s_and_b32 s73, s2, 3
    s_lshl_b32 s73, s73, 1
    s_lshr_b32 s48, s2, 7
    s_add_u32 s73, s73, s48
    s_and_b32 s23, s22, 3
    s_add_u32 s71, s73, s60
    s_and_b32 s71, s71, 7
    s_and_b32 s67, s71, 6
    s_and_b32 s72, s71, 1
    s_and_b32 s49, s23, 1
    s_lshl_b32 s63, s60, 1
    s_add_u32 s63, s63, s49
    s_lshl_b32 s63, s63, 15
    s_mul_i32 s64, s49, 98304
    s_lshl_b32 s48, s73, 7
    s_add_u32 s64, s64, s48
    s_lshl_b32 s65, s49, 12
    s_mul_i32 s66, s49, 12288
    s_add_u32 s66, s66, 65536
    v_lshrrev_b32 v11, 3, v10
    v_and_b32 v12, 7, v10
    v_lshrrev_b32 v13, 4, v10
    v_xor_b32 v14, v12, v13
    v_lshlrev_b32 v15, 10, v11
    v_lshl_add_u32 v2, v14, 4, v15
    v_xor_b32 v3, 64, v2
    v_add_u32 v3, 7168, v3
    v_add_u32 v8, 14336, v2
    v_add_u32 v9, 14336, v3
    v_and_b32 v13, 1, v13
    v_lshlrev_b32 v13, 2, v13
    v_xor_b32 v12, v12, v13
    v_mul_u32_u24 v11, 3072, v11
    v_lshl_add_u32 v4, v12, 4, v11
    v_add_u32 v5, 24576, v4
    v_mov_b32 v6, 0
    s_waitcnt lgkmcnt(0)
    s_mov_b32 s28, s4
    s_mov_b32 s29, s5
    s_mov_b32 s30, 0x200000
    s_mov_b32 s31, 0x00020000
    s_mov_b32 s36, s6
    s_mov_b32 s37, s7
    s_mov_b32 s38, 0x180000
    s_mov_b32 s39, 0x00020000
    s_cmp_lt_u32 s22, 4
    s_cbranch_scc1 L_pro2
    s_cmp_ge_u32 s22, 6
    s_cbranch_scc1 L_prox
    s_add_u32 s69, s67, 0
    s_and_b32 s69, s69, 7
    s_mul_i32 s69, s69, 196608
    s_add_u32 m0, s66, 0
    s_add_u32 s69, s69, s64
    buffer_load_dwordx4 v4, s[36:39], s69 offen offset:0 lds
    buffer_load_dwordx4 v4, s[36:39], s69 offen offset:1024 lds
    buffer_load_dwordx4 v4, s[36:39], s69 offen offset:2048 lds
    s_add_u32 m0, s66, 3072
    s_nop 0
    buffer_load_dwordx4 v5, s[36:39], s69 offen offset:0 lds
    buffer_load_dwordx4 v5, s[36:39], s69 offen offset:1024 lds
    buffer_load_dwordx4 v5, s[36:39], s69 offen offset:2048 lds
    s_add_u32 m0, s66, 6144
    s_add_u32 s69, s69, 49152
    buffer_load_dwordx4 v4, s[36:39], s69 offen offset:0 lds
    buffer_load_dwordx4 v4, s[36:39], s69 offen offset:1024 lds
    buffer_load_dwordx4 v4, s[36:39], s69 offen offset:2048 lds
    s_add_u32 m0, s66, 9216
    s_nop 0
    buffer_load_dwordx4 v5, s[36:39], s69 offen offset:0 lds
    buffer_load_dwordx4 v5, s[36:39], s69 offen offset:1024 lds
    buffer_load_dwordx4 v5, s[36:39], s69 offen offset:2048 lds
    s_add_u32 s69, s67, 1
    s_and_b32 s69, s69, 7
    s_mul_i32 s69, s69, 196608
    s_add_u32 m0, s66, 24576
    s_add_u32 s69, s69, s64
    buffer_load_dwordx4 v4, s[36:39], s69 offen offset:0 lds
    buffer_load_dwordx4 v4, s[36:39], s69 offen offset:1024 lds
    buffer_load_dwordx4 v4, s[36:39], s69 offen offset:2048 lds
    s_add_u32 m0, s66, 27648
    s_nop 0
    buffer_load_dwordx4 v5, s[36:39], s69 offen offset:0 lds
    buffer_load_dwordx4 v5, s[36:39], s69 offen offset:1024 lds
    buffer_load_dwordx4 v5, s[36:39], s69 offen offset:2048 lds
    s_add_u32 m0, s66, 30720
    s_add_u32 s69, s69, 49152
    buffer_load_dwordx4 v4, s[36:39], s69 offen offset:0 lds
    buffer_load_dwordx4 v4, s[36:39], s69 offen offset:1024 lds
    buffer_load_dwordx4 v4, s[36:39], s69 offen offset:2048 lds
    s_add_u32 m0, s66, 33792
    s_nop 0
    buffer_load_dwordx4 v5, s[36:39], s69 offen offset:0 lds
    buffer_load_dwordx4 v5, s[36:39], s69 offen offset:1024 lds
    buffer_load_dwordx4 v5, s[36:39], s69 offen offset:2048 lds
    s_branch L_pro2
L_prox:
    s_add_u32 s68, s67, 0
    s_and_b32 s68, s68, 7
    s_lshl_b32 s68, s68, 7
    s_add_u32 m0, s65, 0
    s_add_u32 s68, s68, s63
    buffer_load_dwordx4 v2, s[28:31], s68 offen offset:0 lds
    buffer_load_dwordx4 v3, s[28:31], s68 offen offset:1024 lds
    buffer_load_dwordx4 v8, s[28:31], s68 offen offset:2048 lds
    buffer_load_dwordx4 v9, s[28:31], s68 offen offset:3072 lds
    s_add_u32 s68, s67, 1
    s_and_b32 s68, s68, 7
    s_lshl_b32 s68, s68, 7
    s_add_u32 m0, s65, 8192
    s_add_u32 s68, s68, s63
    buffer_load_dwordx4 v2, s[28:31], s68 offen offset:0 lds
    buffer_load_dwordx4 v3, s[28:31], s68 offen offset:1024 lds
    buffer_load_dwordx4 v8, s[28:31], s68 offen offset:2048 lds
    buffer_load_dwordx4 v9, s[28:31], s68 offen offset:3072 lds
L_pro2:
    s_mov_b32 s24, s20
    s_mov_b32 s25, s21
    s_mov_b32 s26, 0x1900000
    s_mov_b32 s27, 0x00020000
    s_mov_b32 s32, s16
    s_mov_b32 s33, s17
    s_mov_b32 s34, 0x200000
    s_mov_b32 s35, 0x00020000
    s_mov_b32 s44, s18
    s_mov_b32 s45, s19
    s_mov_b32 s46, 0x100
    s_mov_b32 s47, 0x00020000
    s_mov_b32 s40, s12
    s_mov_b32 s41, s13
    s_mov_b32 s42, 0x1c0000
    s_mov_b32 s43, 0x00020000
    s_mov_b32 s54, 0x0000ffff
    s_mov_b32 s55, 0x0000ffff
    s_getreg_b32 s21, hwreg(HW_REG_XCC_ID, 0, 4)
    s_and_b32 s48, s23, 1
    s_lshl_b32 s62, s60, 1
    s_add_u32 s62, s62, s48
    s_lshr_b32 s48, s23, 1
    s_lshl_b32 s61, s73, 1
    s_add_u32 s61, s61, s48
    s_lshl_b32 s3, s61, 17
    s_lshl_b32 s49, s62, 10
    s_add_u32 s3, s3, s49
    s_cmp_ge_u32 s22, 4
    s_cbranch_scc1 L_help
    s_or_b32 s48, s2, s22
    s_cmp_lg_u32 s48, 0
    s_cbranch_scc1 L_non0
    s_memrealtime s[56:57]
    s_waitcnt lgkmcnt(0)
    s_or_b32 s57, s57, 0x40000000
    v_mov_b32 v84, s56
    v_mov_b32 v85, s57
    s_mov_b64 exec, 1
    buffer_store_dwordx2 v[84:85], v6, s[44:47], 0 offen sc1
    s_mov_b64 exec, -1
L_non0:
    v_and_b32 v11, 31, v10
    v_lshrrev_b32 v12, 5, v10
    v_bfe_u32 v13, v11, 1, 3
    v_xor_b32 v12, v12, v13
    v_lshlrev_b32 v11, 7, v11
    s_and_b32 s48, s23, 1
    s_lshl_b32 s48, s48, 12
    v_add_u32 v11, s48, v11
    v_lshl_add_u32 v120, v12, 4, v11
    v_xor_b32 v121, 32, v120
    v_xor_b32 v122, 64, v120
    v_xor_b32 v123, 96, v120
    v_lshrrev_b32 v11, 5, v10
    v_mul_u32_u24 v11, 3072, v11
    v_bfe_u32 v12, v10, 2, 2
    v_lshl_add_u32 v11, v12, 7, v11
    v_bfe_u32 v12, v10, 3, 1
    s_lshr_b32 s48, s23, 1
    v_xor_b32 v12, s48, v12
    v_lshl_add_u32 v11, v12, 6, v11
    v_bfe_u32 v12, v10, 4, 1
    v_lshl_add_u32 v11, v12, 5, v11
    v_and_b32 v12, 3, v10
    v_lshl_add_u32 v11, v12, 3, v11
    v_add_u32 v124, 65536, v11
    v_add_u32 v125, 114688, v11
    v_mov_b32 v216, 0
    v_mov_b32 v217, 0
    v_mov_b32 v218, 0
    v_mov_b32 v219, 0
    v_lshrrev_b32 v11, 4, v10
    v_lshrrev_b32 v12, 2, v10
    v_xor_b32 v11, v11, v12
    v_and_b32 v11, 1, v11
    v_subrev_u32 v11, 1, v11
    v_and_b32 v80, 0x3f803f80, v11
    v_mov_b32 v81, v80
    v_mov_b32 v82, v80
    v_mov_b32 v83, v80
    v_mov_b32 v16, 0
    v_mov_b32 v17, 0
    v_mov_b32 v18, 0
    v_mov_b32 v19, 0
    v_mov_b32 v20, 0
    v_mov_b32 v21, 0
    v_mov_b32 v22, 0
    v_mov_b32 v23, 0
    v_mov_b32 v24, 0
    v_mov_b32 v25, 0
    v_mov_b32 v26, 0
    v_mov_b32 v27, 0
    v_mov_b32 v28, 0
    v_mov_b32 v29, 0
    v_mov_b32 v30, 0
    v_mov_b32 v31, 0
    v_mov_b32 v32, 0
    v_mov_b32 v33, 0
    v_mov_b32 v34, 0
    v_mov_b32 v35, 0
    v_mov_b32 v36, 0
    v_mov_b32 v37, 0
    v_mov_b32 v38, 0
    v_mov_b32 v39, 0
    v_mov_b32 v40, 0
    v_mov_b32 v41, 0
    v_mov_b32 v42, 0
    v_mov_b32 v43, 0
    v_mov_b32 v44, 0
    v_mov_b32 v45, 0
    v_mov_b32 v46, 0
    v_mov_b32 v47, 0
    v_mov_b32 v48, 0
    v_mov_b32 v49, 0
    v_mov_b32 v50, 0
    v_mov_b32 v51, 0
    v_mov_b32 v52, 0
    v_mov_b32 v53, 0
    v_mov_b32 v54, 0
    v_mov_b32 v55, 0
    v_mov_b32 v56, 0
    v_mov_b32 v57, 0
    v_mov_b32 v58, 0
    v_mov_b32 v59, 0
    v_mov_b32 v60, 0
    v_mov_b32 v61, 0
    v_mov_b32 v62, 0
    v_mov_b32 v63, 0
    v_mov_b32 v64, 0
    v_mov_b32 v65, 0
    v_mov_b32 v66, 0
    v_mov_b32 v67, 0
    v_mov_b32 v68, 0
    v_mov_b32 v69, 0
    v_mov_b32 v70, 0
    v_mov_b32 v71, 0
    v_mov_b32 v72, 0
    v_mov_b32 v73, 0
    v_mov_b32 v74, 0
    v_mov_b32 v75, 0
    v_mov_b32 v76, 0
    v_mov_b32 v77, 0
    v_mov_b32 v78, 0
    v_mov_b32 v79, 0
    v_and_b32 v11, 31, v10
    v_lshlrev_b32 v11, 2, v11
    s_lshl_b32 s48, s23, 10
    v_add_u32 v201, s48, v11
    v_lshrrev_b32 v13, 5, v10
    v_lshlrev_b32 v13, 4, v13
    v_add_u32 v7, s48, v13
    s_lshl_b32 s48, s62, 3
    s_add_u32 s48, s48, s71
    s_lshl_b32 s68, s48, 9
    s_add_u32 s68, s68, 0x1680000
    s_lshl_b32 s48, s61, 5
    s_add_u32 s48, s48, s60
    s_lshl_b32 s69, s48, 9
    s_add_u32 s69, s69, 0x1700000
    v_and_b32 v14, 3, v10
    v_cmp_eq_u32 s[56:57], 1, v14
    s_barrier
    s_waitcnt vmcnt(0)
    buffer_load_dwordx2 v[84:85], v6, s[44:47], 0 offen sc1
    ds_read_b128 v[88:91], v120 offset:0
    ds_read_b64_tr_b16 v[96:97], v124 offset:0
    ds_read_b64_tr_b16 v[98:99], v124 offset:512
    ds_read_b64_tr_b16 v[100:101], v124 offset:1024
    ds_read_b64_tr_b16 v[102:103], v124 offset:1536
    ds_read_b64_tr_b16 v[104:105], v124 offset:2048
    ds_read_b64_tr_b16 v[106:107], v124 offset:2560
    s_cmp_lg_u32 s72, 0
    s_cbranch_scc1 L_cv_sequen_1
    s_waitcnt lgkmcnt(4)
    v_mfma_f32_32x32x16_bf16 v[16:31], v[96:99], v[88:91], v[16:31]
    ds_read_b128 v[92:95], v121 offset:0
    ds_read_b64_tr_b16 v[108:109], v124 offset:6144
    ds_read_b64_tr_b16 v[110:111], v124 offset:6656
    v_mfma_f32_4x4x4_16b_bf16 v[216:219], v[88:89], v[88:89], v[216:219]
    v_mfma_f32_16x16x32_bf16 v[68:71], v[80:83], v[96:99], v[68:71]
    s_waitcnt lgkmcnt(5)
    v_mfma_f32_32x32x16_bf16 v[32:47], v[100:103], v[88:91], v[32:47]
    ds_read_b64_tr_b16 v[112:113], v124 offset:7168
    ds_read_b64_tr_b16 v[114:115], v124 offset:7680
    v_mfma_f32_16x16x32_bf16 v[64:67], v[80:83], v[88:91], v[64:67]
    v_mfma_f32_16x16x32_bf16 v[72:75], v[80:83], v[100:103], v[72:75]
    s_waitcnt lgkmcnt(5)
    v_mfma_f32_4x4x4_16b_bf16 v[216:219], v[90:91], v[90:91], v[216:219]
    v_mfma_f32_16x16x32_bf16 v[76:79], v[80:83], v[104:107], v[76:79]
    v_mfma_f32_32x32x16_bf16 v[48:63], v[88:91], v[104:107], v[48:63]
    ds_read_b64_tr_b16 v[116:117], v124 offset:8192
    ds_read_b64_tr_b16 v[118:119], v124 offset:8704
    s_waitcnt lgkmcnt(4)
    v_mfma_f32_32x32x16_bf16 v[16:31], v[108:111], v[92:95], v[16:31]
    ds_read_b128 v[88:91], v122 offset:0
    ds_read_b64_tr_b16 v[96:97], v124 offset:12288
    ds_read_b64_tr_b16 v[98:99], v124 offset:12800
    v_mfma_f32_4x4x4_16b_bf16 v[216:219], v[92:93], v[92:93], v[216:219]
    v_mfma_f32_16x16x32_bf16 v[68:71], v[80:83], v[108:111], v[68:71]
    s_waitcnt lgkmcnt(5)
    v_mfma_f32_32x32x16_bf16 v[32:47], v[112:115], v[92:95], v[32:47]
    ds_read_b64_tr_b16 v[100:101], v124 offset:13312
    ds_read_b64_tr_b16 v[102:103], v124 offset:13824
    v_mfma_f32_16x16x32_bf16 v[64:67], v[80:83], v[92:95], v[64:67]
    v_mfma_f32_16x16x32_bf16 v[72:75], v[80:83], v[112:115], v[72:75]
    s_waitcnt lgkmcnt(5)
    v_mfma_f32_4x4x4_16b_bf16 v[216:219], v[94:95], v[94:95], v[216:219]
    v_mfma_f32_16x16x32_bf16 v[76:79], v[80:83], v[116:119], v[76:79]
    v_mfma_f32_32x32x16_bf16 v[48:63], v[92:95], v[116:119], v[48:63]
    ds_read_b64_tr_b16 v[104:105], v124 offset:14336
    ds_read_b64_tr_b16 v[106:107], v124 offset:14848
    s_waitcnt lgkmcnt(4)
    v_mfma_f32_32x32x16_bf16 v[16:31], v[96:99], v[88:91], v[16:31]
    ds_read_b128 v[92:95], v123 offset:0
    ds_read_b64_tr_b16 v[108:109], v124 offset:18432
    ds_read_b64_tr_b16 v[110:111], v124 offset:18944
    v_mfma_f32_4x4x4_16b_bf16 v[216:219], v[88:89], v[88:89], v[216:219]
    v_mfma_f32_16x16x32_bf16 v[68:71], v[80:83], v[96:99], v[68:71]
    s_waitcnt lgkmcnt(5)
    v_mfma_f32_32x32x16_bf16 v[32:47], v[100:103], v[88:91], v[32:47]
    ds_read_b64_tr_b16 v[112:113], v124 offset:19456
    ds_read_b64_tr_b16 v[114:115], v124 offset:19968
    v_mfma_f32_16x16x32_bf16 v[64:67], v[80:83], v[88:91], v[64:67]
    v_mfma_f32_16x16x32_bf16 v[72:75], v[80:83], v[100:103], v[72:75]
    s_waitcnt lgkmcnt(5)
    v_mfma_f32_4x4x4_16b_bf16 v[216:219], v[90:91], v[90:91], v[216:219]
    v_mfma_f32_16x16x32_bf16 v[76:79], v[80:83], v[104:107], v[76:79]
    v_mfma_f32_32x32x16_bf16 v[48:63], v[88:91], v[104:107], v[48:63]
    ds_read_b64_tr_b16 v[116:117], v124 offset:20480
    ds_read_b64_tr_b16 v[118:119], v124 offset:20992
    s_barrier
    s_waitcnt lgkmcnt(4)
    v_mfma_f32_32x32x16_bf16 v[16:31], v[108:111], v[92:95], v[16:31]
    ds_read_b128 v[88:91], v120 offset:8192
    ds_read_b64_tr_b16 v[96:97], v124 offset:24576
    ds_read_b64_tr_b16 v[98:99], v124 offset:25088
    v_mfma_f32_4x4x4_16b_bf16 v[216:219], v[92:93], v[92:93], v[216:219]
    v_mfma_f32_16x16x32_bf16 v[68:71], v[80:83], v[108:111], v[68:71]
    s_waitcnt lgkmcnt(5)
    v_mfma_f32_32x32x16_bf16 v[32:47], v[112:115], v[92:95], v[32:47]
    ds_read_b64_tr_b16 v[100:101], v124 offset:25600
    ds_read_b64_tr_b16 v[102:103], v124 offset:26112
    v_mfma_f32_16x16x32_bf16 v[64:67], v[80:83], v[92:95], v[64:67]
    v_mfma_f32_16x16x32_bf16 v[72:75], v[80:83], v[112:115], v[72:75]
    s_waitcnt lgkmcnt(5)
    v_mfma_f32_4x4x4_16b_bf16 v[216:219], v[94:95], v[94:95], v[216:219]
    v_mfma_f32_16x16x32_bf16 v[76:79], v[80:83], v[116:119], v[76:79]
    v_mfma_f32_32x32x16_bf16 v[48:63], v[92:95], v[116:119], v[48:63]
    ds_read_b64_tr_b16 v[104:105], v124 offset:26624
    ds_read_b64_tr_b16 v[106:107], v124 offset:27136
    s_mov_b32 s51, 0
L_nona_sequen_3:
    s_waitcnt vmcnt(0)
    v_readfirstlane_b32 s53, v85
    s_add_u32 s51, s51, 1
    s_cmp_lg_u32 s53, 0
    s_cbranch_scc1 L_nonb_sequen_3
    s_cmp_gt_u32 s51, 400000
    s_cbranch_scc1 L_nonb_sequen_3
    s_sleep 2
    buffer_load_dwordx2 v[84:85], v6, s[44:47], 0 offen sc1
    s_branch L_nona_sequen_3
L_nonb_sequen_3:
    s_waitcnt vmcnt(0)
    s_cmp_lg_u32 s22, 0
    s_cbranch_scc1 L_noxt_sequen_3
    v_mov_b32 v86, s21
    v_mov_b32 v87, 0
    s_and_b32 s48, s2, 7
    s_lshl_b32 s48, s48, 5
    s_lshr_b32 s49, s2, 3
    s_add_u32 s48, s48, s49
    s_lshl_b32 s48, s48, 4
    s_add_u32 s48, s48, 0x17b8000
    s_mov_b64 exec, 1
    buffer_store_dwordx4 v[84:87], v6, s[24:27], s48 offen sc1
    s_mov_b64 exec, -1
L_noxt_sequen_3:
    v_cmp_eq_u32 vcc, 2, v14
    v_mov_b32 v220, v64
    v_mov_b32 v222, v84
    v_mov_b32 v223, v85
    v_cndmask_b32 v221, v216, v217, s[56:57]
    v_cndmask_b32 v221, v221, v218, vcc
    v_cmp_eq_u32 vcc, 3, v14
    v_mov_b32 v224, v68
    v_mov_b32 v225, v72
    v_cndmask_b32 v221, v221, v219, vcc
    v_mov_b32 v15, v221
    v_mov_b32 v226, v76
    v_mov_b32 v227, v84
    v_permlane32_swap_b32 v15, v221
    v_add_f32 v221, v221, v15
    s_mov_b32 exec_hi, 0
    buffer_store_dwordx4 v[224:227], v1, s[24:27], s69 offen sc1
    buffer_store_dwordx4 v[220:223], v1, s[24:27], s68 offen sc1
    s_mov_b32 exec_hi, -1
    s_branch L_cj_sequen_2
L_cv_sequen_1:
    s_waitcnt lgkmcnt(4)
    v_mfma_f32_32x32x16_bf16 v[16:31], v[96:99], v[88:91], v[16:31]
    ds_read_b128 v[92:95], v121 offset:0
    ds_read_b64_tr_b16 v[108:109], v124 offset:6144
    ds_read_b64_tr_b16 v[110:111], v124 offset:6656
    s_waitcnt lgkmcnt(5)
    v_mfma_f32_32x32x16_bf16 v[32:47], v[100:103], v[88:91], v[32:47]
    ds_read_b64_tr_b16 v[112:113], v124 offset:7168
    ds_read_b64_tr_b16 v[114:115], v124 offset:7680
    s_waitcnt lgkmcnt(5)
    v_mfma_f32_32x32x16_bf16 v[48:63], v[88:91], v[104:107], v[48:63]
    ds_read_b64_tr_b16 v[116:117], v124 offset:8192
    ds_read_b64_tr_b16 v[118:119], v124 offset:8704
    s_waitcnt lgkmcnt(4)
    v_mfma_f32_32x32x16_bf16 v[16:31], v[108:111], v[92:95], v[16:31]
    ds_read_b128 v[88:91], v122 offset:0
    ds_read_b64_tr_b16 v[96:97], v124 offset:12288
    ds_read_b64_tr_b16 v[98:99], v124 offset:12800
    s_waitcnt lgkmcnt(5)
    v_mfma_f32_32x32x16_bf16 v[32:47], v[112:115], v[92:95], v[32:47]
    ds_read_b64_tr_b16 v[100:101], v124 offset:13312
    ds_read_b64_tr_b16 v[102:103], v124 offset:13824
    s_waitcnt lgkmcnt(5)
    v_mfma_f32_32x32x16_bf16 v[48:63], v[92:95], v[116:119], v[48:63]
    ds_read_b64_tr_b16 v[104:105], v124 offset:14336
    ds_read_b64_tr_b16 v[106:107], v124 offset:14848
    s_waitcnt lgkmcnt(4)
    v_mfma_f32_32x32x16_bf16 v[16:31], v[96:99], v[88:91], v[16:31]
    ds_read_b128 v[92:95], v123 offset:0
    ds_read_b64_tr_b16 v[108:109], v124 offset:18432
    ds_read_b64_tr_b16 v[110:111], v124 offset:18944
    s_waitcnt lgkmcnt(5)
    v_mfma_f32_32x32x16_bf16 v[32:47], v[100:103], v[88:91], v[32:47]
    ds_read_b64_tr_b16 v[112:113], v124 offset:19456
    ds_read_b64_tr_b16 v[114:115], v124 offset:19968
    s_waitcnt lgkmcnt(5)
    v_mfma_f32_32x32x16_bf16 v[48:63], v[88:91], v[104:107], v[48:63]
    ds_read_b64_tr_b16 v[116:117], v124 offset:20480
    ds_read_b64_tr_b16 v[118:119], v124 offset:20992
    s_barrier
    s_waitcnt lgkmcnt(4)
    v_mfma_f32_32x32x16_bf16 v[16:31], v[108:111], v[92:95], v[16:31]
    ds_read_b128 v[88:91], v120 offset:8192
    ds_read_b64_tr_b16 v[96:97], v124 offset:24576
    ds_read_b64_tr_b16 v[98:99], v124 offset:25088
    s_waitcnt lgkmcnt(5)
    v_mfma_f32_32x32x16_bf16 v[32:47], v[112:115], v[92:95], v[32:47]
    ds_read_b64_tr_b16 v[100:101], v124 offset:25600
    ds_read_b64_tr_b16 v[102:103], v124 offset:26112
    s_waitcnt lgkmcnt(5)
    v_mfma_f32_32x32x16_bf16 v[48:63], v[92:95], v[116:119], v[48:63]
    ds_read_b64_tr_b16 v[104:105], v124 offset:26624
    ds_read_b64_tr_b16 v[106:107], v124 offset:27136
L_cj_sequen_2:
    s_cmp_lg_u32 s72, 1
    s_cbranch_scc1 L_cv_sequen_4
    s_waitcnt lgkmcnt(4)
    v_mfma_f32_32x32x16_bf16 v[16:31], v[96:99], v[88:91], v[16:31]
    ds_read_b128 v[92:95], v121 offset:8192
    ds_read_b64_tr_b16 v[108:109], v124 offset:30720
    ds_read_b64_tr_b16 v[110:111], v124 offset:31232
    v_mfma_f32_4x4x4_16b_bf16 v[216:219], v[88:89], v[88:89], v[216:219]
    v_mfma_f32_16x16x32_bf16 v[68:71], v[80:83], v[96:99], v[68:71]
    s_waitcnt lgkmcnt(5)
    v_mfma_f32_32x32x16_bf16 v[32:47], v[100:103], v[88:91], v[32:47]
    ds_read_b64_tr_b16 v[112:113], v124 offset:31744
    ds_read_b64_tr_b16 v[114:115], v124 offset:32256
    v_mfma_f32_16x16x32_bf16 v[64:67], v[80:83], v[88:91], v[64:67]
    v_mfma_f32_16x16x32_bf16 v[72:75], v[80:83], v[100:103], v[72:75]
    s_waitcnt lgkmcnt(5)
    v_mfma_f32_4x4x4_16b_bf16 v[216:219], v[90:91], v[90:91], v[216:219]
    v_mfma_f32_16x16x32_bf16 v[76:79], v[80:83], v[104:107], v[76:79]
    v_mfma_f32_32x32x16_bf16 v[48:63], v[88:91], v[104:107], v[48:63]
    ds_read_b64_tr_b16 v[116:117], v124 offset:32768
    ds_read_b64_tr_b16 v[118:119], v124 offset:33280
    s_waitcnt lgkmcnt(4)
    v_mfma_f32_32x32x16_bf16 v[16:31], v[108:111], v[92:95], v[16:31]
    ds_read_b128 v[88:91], v122 offset:8192
    ds_read_b64_tr_b16 v[96:97], v124 offset:36864
    ds_read_b64_tr_b16 v[98:99], v124 offset:37376
    v_mfma_f32_4x4x4_16b_bf16 v[216:219], v[92:93], v[92:93], v[216:219]
    v_mfma_f32_16x16x32_bf16 v[68:71], v[80:83], v[108:111], v[68:71]
    s_waitcnt lgkmcnt(5)
    v_mfma_f32_32x32x16_bf16 v[32:47], v[112:115], v[92:95], v[32:47]
    ds_read_b64_tr_b16 v[100:101], v124 offset:37888
    ds_read_b64_tr_b16 v[102:103], v124 offset:38400
    v_mfma_f32_16x16x32_bf16 v[64:67], v[80:83], v[92:95], v[64:67]
    v_mfma_f32_16x16x32_bf16 v[72:75], v[80:83], v[112:115], v[72:75]
    s_waitcnt lgkmcnt(5)
    v_mfma_f32_4x4x4_16b_bf16 v[216:219], v[94:95], v[94:95], v[216:219]
    v_mfma_f32_16x16x32_bf16 v[76:79], v[80:83], v[116:119], v[76:79]
    v_mfma_f32_32x32x16_bf16 v[48:63], v[92:95], v[116:119], v[48:63]
    ds_read_b64_tr_b16 v[104:105], v124 offset:38912
    ds_read_b64_tr_b16 v[106:107], v124 offset:39424
    s_waitcnt lgkmcnt(4)
    v_mfma_f32_32x32x16_bf16 v[16:31], v[96:99], v[88:91], v[16:31]
    ds_read_b128 v[92:95], v123 offset:8192
    ds_read_b64_tr_b16 v[108:109], v124 offset:43008
    ds_read_b64_tr_b16 v[110:111], v124 offset:43520
    v_mfma_f32_4x4x4_16b_bf16 v[216:219], v[88:89], v[88:89], v[216:219]
    v_mfma_f32_16x16x32_bf16 v[68:71], v[80:83], v[96:99], v[68:71]
    s_waitcnt lgkmcnt(5)
    v_mfma_f32_32x32x16_bf16 v[32:47], v[100:103], v[88:91], v[32:47]
    ds_read_b64_tr_b16 v[112:113], v124 offset:44032
    ds_read_b64_tr_b16 v[114:115], v124 offset:44544
    v_mfma_f32_16x16x32_bf16 v[64:67], v[80:83], v[88:91], v[64:67]
    v_mfma_f32_16x16x32_bf16 v[72:75], v[80:83], v[100:103], v[72:75]
    s_waitcnt lgkmcnt(5)
    v_mfma_f32_4x4x4_16b_bf16 v[216:219], v[90:91], v[90:91], v[216:219]
    v_mfma_f32_16x16x32_bf16 v[76:79], v[80:83], v[104:107], v[76:79]
    v_mfma_f32_32x32x16_bf16 v[48:63], v[88:91], v[104:107], v[48:63]
    ds_read_b64_tr_b16 v[116:117], v124 offset:45056
    ds_read_b64_tr_b16 v[118:119], v124 offset:45568
    s_barrier
    s_waitcnt lgkmcnt(4)
    v_mfma_f32_32x32x16_bf16 v[16:31], v[108:111], v[92:95], v[16:31]
    ds_read_b128 v[88:91], v120 offset:16384
    ds_read_b64_tr_b16 v[96:97], v125 offset:0
    ds_read_b64_tr_b16 v[98:99], v125 offset:512
    v_mfma_f32_4x4x4_16b_bf16 v[216:219], v[92:93], v[92:93], v[216:219]
    v_mfma_f32_16x16x32_bf16 v[68:71], v[80:83], v[108:111], v[68:71]
    s_waitcnt lgkmcnt(5)
    v_mfma_f32_32x32x16_bf16 v[32:47], v[112:115], v[92:95], v[32:47]
    ds_read_b64_tr_b16 v[100:101], v125 offset:1024
    ds_read_b64_tr_b16 v[102:103], v125 offset:1536
    v_mfma_f32_16x16x32_bf16 v[64:67], v[80:83], v[92:95], v[64:67]
    v_mfma_f32_16x16x32_bf16 v[72:75], v[80:83], v[112:115], v[72:75]
    s_waitcnt lgkmcnt(5)
    v_mfma_f32_4x4x4_16b_bf16 v[216:219], v[94:95], v[94:95], v[216:219]
    v_mfma_f32_16x16x32_bf16 v[76:79], v[80:83], v[116:119], v[76:79]
    v_mfma_f32_32x32x16_bf16 v[48:63], v[92:95], v[116:119], v[48:63]
    ds_read_b64_tr_b16 v[104:105], v125 offset:2048
    ds_read_b64_tr_b16 v[106:107], v125 offset:2560
    s_mov_b32 s51, 0
L_nona_sequen_6:
    s_waitcnt vmcnt(0)
    v_readfirstlane_b32 s53, v85
    s_add_u32 s51, s51, 1
    s_cmp_lg_u32 s53, 0
    s_cbranch_scc1 L_nonb_sequen_6
    s_cmp_gt_u32 s51, 400000
    s_cbranch_scc1 L_nonb_sequen_6
    s_sleep 2
    buffer_load_dwordx2 v[84:85], v6, s[44:47], 0 offen sc1
    s_branch L_nona_sequen_6
L_nonb_sequen_6:
    s_waitcnt vmcnt(0)
    s_cmp_lg_u32 s22, 0
    s_cbranch_scc1 L_noxt_sequen_6
    v_mov_b32 v86, s21
    v_mov_b32 v87, 0
    s_and_b32 s48, s2, 7
    s_lshl_b32 s48, s48, 5
    s_lshr_b32 s49, s2, 3
    s_add_u32 s48, s48, s49
    s_lshl_b32 s48, s48, 4
    s_add_u32 s48, s48, 0x17b8000
    s_mov_b64 exec, 1
    buffer_store_dwordx4 v[84:87], v6, s[24:27], s48 offen sc1
    s_mov_b64 exec, -1
L_noxt_sequen_6:
    v_cmp_eq_u32 vcc, 2, v14
    v_mov_b32 v220, v64
    v_mov_b32 v222, v84
    v_mov_b32 v223, v85
    v_cndmask_b32 v221, v216, v217, s[56:57]
    v_cndmask_b32 v221, v221, v218, vcc
    v_cmp_eq_u32 vcc, 3, v14
    v_mov_b32 v224, v68
    v_mov_b32 v225, v72
    v_cndmask_b32 v221, v221, v219, vcc
    v_mov_b32 v15, v221
    v_mov_b32 v226, v76
    v_mov_b32 v227, v84
    v_permlane32_swap_b32 v15, v221
    v_add_f32 v221, v221, v15
    s_mov_b32 exec_hi, 0
    buffer_store_dwordx4 v[224:227], v1, s[24:27], s69 offen sc1
    buffer_store_dwordx4 v[220:223], v1, s[24:27], s68 offen sc1
    s_mov_b32 exec_hi, -1
    s_branch L_cj_sequen_5
L_cv_sequen_4:
    s_waitcnt lgkmcnt(4)
    v_mfma_f32_32x32x16_bf16 v[16:31], v[96:99], v[88:91], v[16:31]
    ds_read_b128 v[92:95], v121 offset:8192
    ds_read_b64_tr_b16 v[108:109], v124 offset:30720
    ds_read_b64_tr_b16 v[110:111], v124 offset:31232
    s_waitcnt lgkmcnt(5)
    v_mfma_f32_32x32x16_bf16 v[32:47], v[100:103], v[88:91], v[32:47]
    ds_read_b64_tr_b16 v[112:113], v124 offset:31744
    ds_read_b64_tr_b16 v[114:115], v124 offset:32256
    s_waitcnt lgkmcnt(5)
    v_mfma_f32_32x32x16_bf16 v[48:63], v[88:91], v[104:107], v[48:63]
    ds_read_b64_tr_b16 v[116:117], v124 offset:32768
    ds_read_b64_tr_b16 v[118:119], v124 offset:33280
    s_waitcnt lgkmcnt(4)
    v_mfma_f32_32x32x16_bf16 v[16:31], v[108:111], v[92:95], v[16:31]
    ds_read_b128 v[88:91], v122 offset:8192
    ds_read_b64_tr_b16 v[96:97], v124 offset:36864
    ds_read_b64_tr_b16 v[98:99], v124 offset:37376
    s_waitcnt lgkmcnt(5)
    v_mfma_f32_32x32x16_bf16 v[32:47], v[112:115], v[92:95], v[32:47]
    ds_read_b64_tr_b16 v[100:101], v124 offset:37888
    ds_read_b64_tr_b16 v[102:103], v124 offset:38400
    s_waitcnt lgkmcnt(5)
    v_mfma_f32_32x32x16_bf16 v[48:63], v[92:95], v[116:119], v[48:63]
    ds_read_b64_tr_b16 v[104:105], v124 offset:38912
    ds_read_b64_tr_b16 v[106:107], v124 offset:39424
    s_waitcnt lgkmcnt(4)
    v_mfma_f32_32x32x16_bf16 v[16:31], v[96:99], v[88:91], v[16:31]
    ds_read_b128 v[92:95], v123 offset:8192
    ds_read_b64_tr_b16 v[108:109], v124 offset:43008
    ds_read_b64_tr_b16 v[110:111], v124 offset:43520
    s_waitcnt lgkmcnt(5)
    v_mfma_f32_32x32x16_bf16 v[32:47], v[100:103], v[88:91], v[32:47]
    ds_read_b64_tr_b16 v[112:113], v124 offset:44032
    ds_read_b64_tr_b16 v[114:115], v124 offset:44544
    s_waitcnt lgkmcnt(5)
    v_mfma_f32_32x32x16_bf16 v[48:63], v[88:91], v[104:107], v[48:63]
    ds_read_b64_tr_b16 v[116:117], v124 offset:45056
    ds_read_b64_tr_b16 v[118:119], v124 offset:45568
    s_barrier
    s_waitcnt lgkmcnt(4)
    v_mfma_f32_32x32x16_bf16 v[16:31], v[108:111], v[92:95], v[16:31]
    ds_read_b128 v[88:91], v120 offset:16384
    ds_read_b64_tr_b16 v[96:97], v125 offset:0
    ds_read_b64_tr_b16 v[98:99], v125 offset:512
    s_waitcnt lgkmcnt(5)
    v_mfma_f32_32x32x16_bf16 v[32:47], v[112:115], v[92:95], v[32:47]
    ds_read_b64_tr_b16 v[100:101], v125 offset:1024
    ds_read_b64_tr_b16 v[102:103], v125 offset:1536
    s_waitcnt lgkmcnt(5)
    v_mfma_f32_32x32x16_bf16 v[48:63], v[92:95], v[116:119], v[48:63]
    ds_read_b64_tr_b16 v[104:105], v125 offset:2048
    ds_read_b64_tr_b16 v[106:107], v125 offset:2560
L_cj_sequen_5:
    s_waitcnt lgkmcnt(4)
    v_mfma_f32_32x32x16_bf16 v[16:31], v[96:99], v[88:91], v[16:31]
    ds_read_b128 v[92:95], v121 offset:16384
    ds_read_b64_tr_b16 v[108:109], v125 offset:6144
    ds_read_b64_tr_b16 v[110:111], v125 offset:6656
    s_waitcnt lgkmcnt(5)
    v_mfma_f32_32x32x16_bf16 v[32:47], v[100:103], v[88:91], v[32:47]
    ds_read_b64_tr_b16 v[112:113], v125 offset:7168
    ds_read_b64_tr_b16 v[114:115], v125 offset:7680
    s_waitcnt lgkmcnt(5)
    v_mfma_f32_32x32x16_bf16 v[48:63], v[88:91], v[104:107], v[48:63]
    ds_read_b64_tr_b16 v[116:117], v125 offset:8192
    ds_read_b64_tr_b16 v[118:119], v125 offset:8704
    s_waitcnt lgkmcnt(4)
    v_mfma_f32_32x32x16_bf16 v[16:31], v[108:111], v[92:95], v[16:31]
    ds_read_b128 v[88:91], v122 offset:16384
    ds_read_b64_tr_b16 v[96:97], v125 offset:12288
    ds_read_b64_tr_b16 v[98:99], v125 offset:12800
    s_waitcnt lgkmcnt(5)
    v_mfma_f32_32x32x16_bf16 v[32:47], v[112:115], v[92:95], v[32:47]
    ds_read_b64_tr_b16 v[100:101], v125 offset:13312
    ds_read_b64_tr_b16 v[102:103], v125 offset:13824
    s_waitcnt lgkmcnt(5)
    v_mfma_f32_32x32x16_bf16 v[48:63], v[92:95], v[116:119], v[48:63]
    ds_read_b64_tr_b16 v[104:105], v125 offset:14336
    ds_read_b64_tr_b16 v[106:107], v125 offset:14848
    s_waitcnt lgkmcnt(4)
    v_mfma_f32_32x32x16_bf16 v[16:31], v[96:99], v[88:91], v[16:31]
    ds_read_b128 v[92:95], v123 offset:16384
    ds_read_b64_tr_b16 v[108:109], v125 offset:18432
    ds_read_b64_tr_b16 v[110:111], v125 offset:18944
    s_waitcnt lgkmcnt(5)
    v_mfma_f32_32x32x16_bf16 v[32:47], v[100:103], v[88:91], v[32:47]
    ds_read_b64_tr_b16 v[112:113], v125 offset:19456
    ds_read_b64_tr_b16 v[114:115], v125 offset:19968
    s_waitcnt lgkmcnt(5)
    v_mfma_f32_32x32x16_bf16 v[48:63], v[88:91], v[104:107], v[48:63]
    ds_read_b64_tr_b16 v[116:117], v125 offset:20480
    ds_read_b64_tr_b16 v[118:119], v125 offset:20992
    s_barrier
    s_waitcnt lgkmcnt(4)
    v_mfma_f32_32x32x16_bf16 v[16:31], v[108:111], v[92:95], v[16:31]
    ds_read_b128 v[88:91], v120 offset:24576
    ds_read_b64_tr_b16 v[96:97], v125 offset:24576
    ds_read_b64_tr_b16 v[98:99], v125 offset:25088
    s_waitcnt lgkmcnt(5)
    v_mfma_f32_32x32x16_bf16 v[32:47], v[112:115], v[92:95], v[32:47]
    ds_read_b64_tr_b16 v[100:101], v125 offset:25600
    ds_read_b64_tr_b16 v[102:103], v125 offset:26112
    s_waitcnt lgkmcnt(5)
    v_mfma_f32_32x32x16_bf16 v[48:63], v[92:95], v[116:119], v[48:63]
    ds_read_b64_tr_b16 v[104:105], v125 offset:26624
    ds_read_b64_tr_b16 v[106:107], v125 offset:27136
    s_waitcnt lgkmcnt(4)
    v_mfma_f32_32x32x16_bf16 v[16:31], v[96:99], v[88:91], v[16:31]
    ds_read_b128 v[92:95], v121 offset:24576
    ds_read_b64_tr_b16 v[108:109], v125 offset:30720
    ds_read_b64_tr_b16 v[110:111], v125 offset:31232
    s_waitcnt lgkmcnt(5)
    v_mfma_f32_32x32x16_bf16 v[32:47], v[100:103], v[88:91], v[32:47]
    ds_read_b64_tr_b16 v[112:113], v125 offset:31744
    ds_read_b64_tr_b16 v[114:115], v125 offset:32256
    s_waitcnt lgkmcnt(5)
    v_mfma_f32_32x32x16_bf16 v[48:63], v[88:91], v[104:107], v[48:63]
    ds_read_b64_tr_b16 v[116:117], v125 offset:32768
    ds_read_b64_tr_b16 v[118:119], v125 offset:33280
    s_waitcnt lgkmcnt(4)
    v_mfma_f32_32x32x16_bf16 v[16:31], v[108:111], v[92:95], v[16:31]
    ds_read_b128 v[88:91], v122 offset:24576
    ds_read_b64_tr_b16 v[96:97], v125 offset:36864
    ds_read_b64_tr_b16 v[98:99], v125 offset:37376
    s_waitcnt lgkmcnt(5)
    v_mfma_f32_32x32x16_bf16 v[32:47], v[112:115], v[92:95], v[32:47]
    ds_read_b64_tr_b16 v[100:101], v125 offset:37888
    ds_read_b64_tr_b16 v[102:103], v125 offset:38400
    s_waitcnt lgkmcnt(5)
    v_mfma_f32_32x32x16_bf16 v[48:63], v[92:95], v[116:119], v[48:63]
    ds_read_b64_tr_b16 v[104:105], v125 offset:38912
    ds_read_b64_tr_b16 v[106:107], v125 offset:39424
    s_waitcnt lgkmcnt(4)
    v_mfma_f32_32x32x16_bf16 v[16:31], v[96:99], v[88:91], v[16:31]
    ds_read_b128 v[92:95], v123 offset:24576
    ds_read_b64_tr_b16 v[108:109], v125 offset:43008
    ds_read_b64_tr_b16 v[110:111], v125 offset:43520
    s_waitcnt lgkmcnt(5)
    v_mfma_f32_32x32x16_bf16 v[32:47], v[100:103], v[88:91], v[32:47]
    ds_read_b64_tr_b16 v[112:113], v125 offset:44032
    ds_read_b64_tr_b16 v[114:115], v125 offset:44544
    s_waitcnt lgkmcnt(5)
    v_mfma_f32_32x32x16_bf16 v[48:63], v[88:91], v[104:107], v[48:63]
    ds_read_b64_tr_b16 v[116:117], v125 offset:45056
    ds_read_b64_tr_b16 v[118:119], v125 offset:45568
    s_barrier
    s_waitcnt lgkmcnt(4)
    v_mfma_f32_32x32x16_bf16 v[16:31], v[108:111], v[92:95], v[16:31]
    ds_read_b128 v[88:91], v120 offset:32768
    ds_read_b64_tr_b16 v[96:97], v124 offset:0
    ds_read_b64_tr_b16 v[98:99], v124 offset:512
    s_waitcnt lgkmcnt(5)
    v_mfma_f32_32x32x16_bf16 v[32:47], v[112:115], v[92:95], v[32:47]
    ds_read_b64_tr_b16 v[100:101], v124 offset:1024
    ds_read_b64_tr_b16 v[102:103], v124 offset:1536
    s_waitcnt lgkmcnt(5)
    v_mfma_f32_32x32x16_bf16 v[48:63], v[92:95], v[116:119], v[48:63]
    ds_read_b64_tr_b16 v[104:105], v124 offset:2048
    ds_read_b64_tr_b16 v[106:107], v124 offset:2560
    s_waitcnt lgkmcnt(4)
    v_mfma_f32_32x32x16_bf16 v[16:31], v[96:99], v[88:91], v[16:31]
    ds_read_b128 v[92:95], v121 offset:32768
    ds_read_b64_tr_b16 v[108:109], v124 offset:6144
    ds_read_b64_tr_b16 v[110:111], v124 offset:6656
    s_waitcnt lgkmcnt(5)
    v_mfma_f32_32x32x16_bf16 v[32:47], v[100:103], v[88:91], v[32:47]
    ds_read_b64_tr_b16 v[112:113], v124 offset:7168
    ds_read_b64_tr_b16 v[114:115], v124 offset:7680
    s_waitcnt lgkmcnt(5)
    v_mfma_f32_32x32x16_bf16 v[48:63], v[88:91], v[104:107], v[48:63]
    ds_read_b64_tr_b16 v[116:117], v124 offset:8192
    ds_read_b64_tr_b16 v[118:119], v124 offset:8704
    s_waitcnt lgkmcnt(4)
    v_mfma_f32_32x32x16_bf16 v[16:31], v[108:111], v[92:95], v[16:31]
    ds_read_b128 v[88:91], v122 offset:32768
    ds_read_b64_tr_b16 v[96:97], v124 offset:12288
    ds_read_b64_tr_b16 v[98:99], v124 offset:12800
    s_waitcnt lgkmcnt(5)
    v_mfma_f32_32x32x16_bf16 v[32:47], v[112:115], v[92:95], v[32:47]
    ds_read_b64_tr_b16 v[100:101], v124 offset:13312
    ds_read_b64_tr_b16 v[102:103], v124 offset:13824
    s_waitcnt lgkmcnt(5)
    v_mfma_f32_32x32x16_bf16 v[48:63], v[92:95], v[116:119], v[48:63]
    ds_read_b64_tr_b16 v[104:105], v124 offset:14336
    ds_read_b64_tr_b16 v[106:107], v124 offset:14848
    s_waitcnt lgkmcnt(4)
    v_mfma_f32_32x32x16_bf16 v[16:31], v[96:99], v[88:91], v[16:31]
    ds_read_b128 v[92:95], v123 offset:32768
    ds_read_b64_tr_b16 v[108:109], v124 offset:18432
    ds_read_b64_tr_b16 v[110:111], v124 offset:18944
    s_waitcnt lgkmcnt(5)
    v_mfma_f32_32x32x16_bf16 v[32:47], v[100:103], v[88:91], v[32:47]
    ds_read_b64_tr_b16 v[112:113], v124 offset:19456
    ds_read_b64_tr_b16 v[114:115], v124 offset:19968
    s_waitcnt lgkmcnt(5)
    v_mfma_f32_32x32x16_bf16 v[48:63], v[88:91], v[104:107], v[48:63]
    ds_read_b64_tr_b16 v[116:117], v124 offset:20480
    ds_read_b64_tr_b16 v[118:119], v124 offset:20992
    s_barrier
    s_waitcnt lgkmcnt(4)
    v_mfma_f32_32x32x16_bf16 v[16:31], v[108:111], v[92:95], v[16:31]
    ds_read_b128 v[88:91], v120 offset:40960
    ds_read_b64_tr_b16 v[96:97], v124 offset:24576
    ds_read_b64_tr_b16 v[98:99], v124 offset:25088
    s_waitcnt lgkmcnt(5)
    v_mfma_f32_32x32x16_bf16 v[32:47], v[112:115], v[92:95], v[32:47]
    ds_read_b64_tr_b16 v[100:101], v124 offset:25600
    ds_read_b64_tr_b16 v[102:103], v124 offset:26112
    s_waitcnt lgkmcnt(5)
    v_mfma_f32_32x32x16_bf16 v[48:63], v[92:95], v[116:119], v[48:63]
    ds_read_b64_tr_b16 v[104:105], v124 offset:26624
    ds_read_b64_tr_b16 v[106:107], v124 offset:27136
    s_waitcnt lgkmcnt(4)
    v_mfma_f32_32x32x16_bf16 v[16:31], v[96:99], v[88:91], v[16:31]
    ds_read_b128 v[92:95], v121 offset:40960
    ds_read_b64_tr_b16 v[108:109], v124 offset:30720
    ds_read_b64_tr_b16 v[110:111], v124 offset:31232
    s_waitcnt lgkmcnt(5)
    v_mfma_f32_32x32x16_bf16 v[32:47], v[100:103], v[88:91], v[32:47]
    ds_read_b64_tr_b16 v[112:113], v124 offset:31744
    ds_read_b64_tr_b16 v[114:115], v124 offset:32256
    s_waitcnt lgkmcnt(5)
    v_mfma_f32_32x32x16_bf16 v[48:63], v[88:91], v[104:107], v[48:63]
    ds_read_b64_tr_b16 v[116:117], v124 offset:32768
    ds_read_b64_tr_b16 v[118:119], v124 offset:33280
    s_waitcnt lgkmcnt(4)
    v_mfma_f32_32x32x16_bf16 v[16:31], v[108:111], v[92:95], v[16:31]
    ds_read_b128 v[88:91], v122 offset:40960
    ds_read_b64_tr_b16 v[96:97], v124 offset:36864
    ds_read_b64_tr_b16 v[98:99], v124 offset:37376
    s_waitcnt lgkmcnt(5)
    v_mfma_f32_32x32x16_bf16 v[32:47], v[112:115], v[92:95], v[32:47]
    ds_read_b64_tr_b16 v[100:101], v124 offset:37888
    ds_read_b64_tr_b16 v[102:103], v124 offset:38400
    s_waitcnt lgkmcnt(5)
    v_mfma_f32_32x32x16_bf16 v[48:63], v[92:95], v[116:119], v[48:63]
    ds_read_b64_tr_b16 v[104:105], v124 offset:38912
    ds_read_b64_tr_b16 v[106:107], v124 offset:39424
    s_waitcnt lgkmcnt(4)
    v_mfma_f32_32x32x16_bf16 v[16:31], v[96:99], v[88:91], v[16:31]
    ds_read_b128 v[92:95], v123 offset:40960
    ds_read_b64_tr_b16 v[108:109], v124 offset:43008
    ds_read_b64_tr_b16 v[110:111], v124 offset:43520
    s_waitcnt lgkmcnt(5)
    v_mfma_f32_32x32x16_bf16 v[32:47], v[100:103], v[88:91], v[32:47]
    ds_read_b64_tr_b16 v[112:113], v124 offset:44032
    ds_read_b64_tr_b16 v[114:115], v124 offset:44544
    s_waitcnt lgkmcnt(5)
    v_mfma_f32_32x32x16_bf16 v[48:63], v[88:91], v[104:107], v[48:63]
    ds_read_b64_tr_b16 v[116:117], v124 offset:45056
    ds_read_b64_tr_b16 v[118:119], v124 offset:45568
    s_barrier
    s_waitcnt lgkmcnt(4)
    v_mfma_f32_32x32x16_bf16 v[16:31], v[108:111], v[92:95], v[16:31]
    ds_read_b128 v[88:91], v120 offset:49152
    ds_read_b64_tr_b16 v[96:97], v125 offset:0
    ds_read_b64_tr_b16 v[98:99], v125 offset:512
    s_waitcnt lgkmcnt(5)
    v_mfma_f32_32x32x16_bf16 v[32:47], v[112:115], v[92:95], v[32:47]
    ds_read_b64_tr_b16 v[100:101], v125 offset:1024
    ds_read_b64_tr_b16 v[102:103], v125 offset:1536
    s_waitcnt lgkmcnt(5)
    v_mfma_f32_32x32x16_bf16 v[48:63], v[92:95], v[116:119], v[48:63]
    ds_read_b64_tr_b16 v[104:105], v125 offset:2048
    ds_read_b64_tr_b16 v[106:107], v125 offset:2560
    s_waitcnt lgkmcnt(4)
    v_mfma_f32_32x32x16_bf16 v[16:31], v[96:99], v[88:91], v[16:31]
    ds_read_b128 v[92:95], v121 offset:49152
    ds_read_b64_tr_b16 v[108:109], v125 offset:6144
    ds_read_b64_tr_b16 v[110:111], v125 offset:6656
    s_waitcnt lgkmcnt(5)
    v_mfma_f32_32x32x16_bf16 v[32:47], v[100:103], v[88:91], v[32:47]
    ds_read_b64_tr_b16 v[112:113], v125 offset:7168
    ds_read_b64_tr_b16 v[114:115], v125 offset:7680
    s_waitcnt lgkmcnt(5)
    v_mfma_f32_32x32x16_bf16 v[48:63], v[88:91], v[104:107], v[48:63]
    ds_read_b64_tr_b16 v[116:117], v125 offset:8192
    ds_read_b64_tr_b16 v[118:119], v125 offset:8704
    s_waitcnt lgkmcnt(4)
    v_mfma_f32_32x32x16_bf16 v[16:31], v[108:111], v[92:95], v[16:31]
    ds_read_b128 v[88:91], v122 offset:49152
    ds_read_b64_tr_b16 v[96:97], v125 offset:12288
    ds_read_b64_tr_b16 v[98:99], v125 offset:12800
    s_waitcnt lgkmcnt(5)
    v_mfma_f32_32x32x16_bf16 v[32:47], v[112:115], v[92:95], v[32:47]
    ds_read_b64_tr_b16 v[100:101], v125 offset:13312
    ds_read_b64_tr_b16 v[102:103], v125 offset:13824
    s_waitcnt lgkmcnt(5)
    v_mfma_f32_32x32x16_bf16 v[48:63], v[92:95], v[116:119], v[48:63]
    ds_read_b64_tr_b16 v[104:105], v125 offset:14336
    ds_read_b64_tr_b16 v[106:107], v125 offset:14848
    s_waitcnt lgkmcnt(4)
    v_mfma_f32_32x32x16_bf16 v[16:31], v[96:99], v[88:91], v[16:31]
    ds_read_b128 v[92:95], v123 offset:49152
    ds_read_b64_tr_b16 v[108:109], v125 offset:18432
    ds_read_b64_tr_b16 v[110:111], v125 offset:18944
    s_waitcnt lgkmcnt(5)
    v_mfma_f32_32x32x16_bf16 v[32:47], v[100:103], v[88:91], v[32:47]
    ds_read_b64_tr_b16 v[112:113], v125 offset:19456
    ds_read_b64_tr_b16 v[114:115], v125 offset:19968
    s_waitcnt lgkmcnt(5)
    v_mfma_f32_32x32x16_bf16 v[48:63], v[88:91], v[104:107], v[48:63]
    ds_read_b64_tr_b16 v[116:117], v125 offset:20480
    ds_read_b64_tr_b16 v[118:119], v125 offset:20992
    s_barrier
    s_waitcnt lgkmcnt(4)
    v_mfma_f32_32x32x16_bf16 v[16:31], v[108:111], v[92:95], v[16:31]
    ds_read_b128 v[88:91], v120 offset:57344
    ds_read_b64_tr_b16 v[96:97], v125 offset:24576
    ds_read_b64_tr_b16 v[98:99], v125 offset:25088
    s_waitcnt lgkmcnt(5)
    v_mfma_f32_32x32x16_bf16 v[32:47], v[112:115], v[92:95], v[32:47]
    ds_read_b64_tr_b16 v[100:101], v125 offset:25600
    ds_read_b64_tr_b16 v[102:103], v125 offset:26112
    s_waitcnt lgkmcnt(5)
    v_mfma_f32_32x32x16_bf16 v[48:63], v[92:95], v[116:119], v[48:63]
    ds_read_b64_tr_b16 v[104:105], v125 offset:26624
    ds_read_b64_tr_b16 v[106:107], v125 offset:27136
    s_waitcnt lgkmcnt(4)
    v_mfma_f32_32x32x16_bf16 v[16:31], v[96:99], v[88:91], v[16:31]
    ds_read_b128 v[92:95], v121 offset:57344
    ds_read_b64_tr_b16 v[108:109], v125 offset:30720
    ds_read_b64_tr_b16 v[110:111], v125 offset:31232
    s_waitcnt lgkmcnt(5)
    v_mfma_f32_32x32x16_bf16 v[32:47], v[100:103], v[88:91], v[32:47]
    ds_read_b64_tr_b16 v[112:113], v125 offset:31744
    ds_read_b64_tr_b16 v[114:115], v125 offset:32256
    s_waitcnt lgkmcnt(5)
    v_mfma_f32_32x32x16_bf16 v[48:63], v[88:91], v[104:107], v[48:63]
    ds_read_b64_tr_b16 v[116:117], v125 offset:32768
    ds_read_b64_tr_b16 v[118:119], v125 offset:33280
    s_waitcnt lgkmcnt(4)
    v_mfma_f32_32x32x16_bf16 v[16:31], v[108:111], v[92:95], v[16:31]
    ds_read_b128 v[88:91], v122 offset:57344
    ds_read_b64_tr_b16 v[96:97], v125 offset:36864
    ds_read_b64_tr_b16 v[98:99], v125 offset:37376
    s_waitcnt lgkmcnt(5)
    v_mfma_f32_32x32x16_bf16 v[32:47], v[112:115], v[92:95], v[32:47]
    ds_read_b64_tr_b16 v[100:101], v125 offset:37888
    ds_read_b64_tr_b16 v[102:103], v125 offset:38400
    s_waitcnt lgkmcnt(5)
    v_mfma_f32_32x32x16_bf16 v[48:63], v[92:95], v[116:119], v[48:63]
    ds_read_b64_tr_b16 v[104:105], v125 offset:38912
    ds_read_b64_tr_b16 v[106:107], v125 offset:39424
    s_waitcnt lgkmcnt(4)
    v_mfma_f32_32x32x16_bf16 v[16:31], v[96:99], v[88:91], v[16:31]
    ds_read_b128 v[92:95], v123 offset:57344
    ds_read_b64_tr_b16 v[108:109], v125 offset:43008
    ds_read_b64_tr_b16 v[110:111], v125 offset:43520
    s_waitcnt lgkmcnt(5)
    v_mfma_f32_32x32x16_bf16 v[32:47], v[100:103], v[88:91], v[32:47]
    ds_read_b64_tr_b16 v[112:113], v125 offset:44032
    ds_read_b64_tr_b16 v[114:115], v125 offset:44544
    s_waitcnt lgkmcnt(5)
    v_mfma_f32_32x32x16_bf16 v[48:63], v[88:91], v[104:107], v[48:63]
    ds_read_b64_tr_b16 v[116:117], v125 offset:45056
    ds_read_b64_tr_b16 v[118:119], v125 offset:45568
    s_barrier
    s_waitcnt lgkmcnt(0)
    ds_read_b32 v205, v201 offset:640
    ds_read_b32 v204, v201 offset:512
    ds_read_b128 v[132:135], v7 offset:0
    ds_read_b128 v[136:139], v7 offset:32
    ds_read_b128 v[140:143], v7 offset:64
    ds_read_b128 v[144:147], v7 offset:96
    ds_read_b128 v[148:151], v7 offset:128
    ds_read_b128 v[152:155], v7 offset:160
    ds_read_b128 v[156:159], v7 offset:192
    ds_read_b128 v[160:163], v7 offset:224
    ds_read_b32 v8, v201
    ds_read_b32 v9, v201 offset:128
    v_mfma_f32_32x32x16_bf16 v[16:31], v[108:111], v[92:95], v[16:31]
    ds_read_b128 v[180:183], v7 offset:384
    ds_read_b128 v[184:187], v7 offset:416
    ds_read_b128 v[188:191], v7 offset:448
    ds_read_b128 v[192:195], v7 offset:480
    v_mfma_f32_32x32x16_bf16 v[32:47], v[112:115], v[92:95], v[32:47]
    ds_read_b128 v[164:167], v7 offset:256
    ds_read_b128 v[168:171], v7 offset:288
    ds_read_b128 v[172:175], v7 offset:320
    ds_read_b128 v[176:179], v7 offset:352
    v_mfma_f32_32x32x16_bf16 v[48:63], v[92:95], v[116:119], v[48:63]
    v_bfe_u32 v3, v10, 4, 1
    v_lshlrev_b32 v3, 16, v3
    v_lshrrev_b32 v4, 5, v10
    v_lshl_add_u32 v3, v4, 8, v3
    v_and_b32 v4, 15, v10
    v_lshl_add_u32 v3, v4, 4, v3
    s_waitcnt lgkmcnt(10)
    v_readfirstlane_b32 s70, v205
    s_nop 3
    v_mul_f32 v148, v148, v204
    v_fma_f32 v48, v48, v132, v148
    v_mul_f32 v149, v149, v204
    v_fma_f32 v49, v49, v133, v149
    v_mul_f32 v150, v150, v204
    v_fma_f32 v50, v50, v134, v150
    v_mul_f32 v151, v151, v204
    v_fma_f32 v51, v51, v135, v151
    v_mul_f32 v152, v152, v204
    v_fma_f32 v52, v52, v136, v152
    v_mul_f32 v153, v153, v204
    v_fma_f32 v53, v53, v137, v153
    v_mul_f32 v154, v154, v204
    v_fma_f32 v54, v54, v138, v154
    v_mul_f32 v155, v155, v204
    v_fma_f32 v55, v55, v139, v155
    v_mul_f32 v156, v156, v204
    v_fma_f32 v56, v56, v140, v156
    v_mul_f32 v157, v157, v204
    v_fma_f32 v57, v57, v141, v157
    v_mul_f32 v158, v158, v204
    v_fma_f32 v58, v58, v142, v158
    v_mul_f32 v159, v159, v204
    v_fma_f32 v59, v59, v143, v159
    v_mul_f32 v160, v160, v204
    v_fma_f32 v60, v60, v144, v160
    v_mul_f32 v161, v161, v204
    v_fma_f32 v61, v61, v145, v161
    v_mul_f32 v162, v162, v204
    v_fma_f32 v62, v62, v146, v162
    v_mul_f32 v163, v163, v204
    v_fma_f32 v63, v63, v147, v163
    v_cvt_pk_bf16_f32 v48, v48, v49
    v_cvt_pk_bf16_f32 v49, v50, v51
    v_cvt_pk_bf16_f32 v50, v52, v53
    v_cvt_pk_bf16_f32 v51, v54, v55
    v_cvt_pk_bf16_f32 v52, v56, v57
    v_cvt_pk_bf16_f32 v53, v58, v59
    v_cvt_pk_bf16_f32 v54, v60, v61
    v_cvt_pk_bf16_f32 v55, v62, v63
    s_add_u32 s49, s3, 0x400000
    buffer_store_dwordx4 v[48:51], v3, s[24:27], s49 offen sc1
    buffer_store_dwordx4 v[52:55], v3, s[24:27], s49 offen offset:512 sc1
    s_waitcnt lgkmcnt(4)
    v_mul_f32 v180, v180, v9
    v_fma_f32 v32, v32, v8, v180
    v_mul_f32 v181, v181, v9
    v_fma_f32 v33, v33, v8, v181
    v_mul_f32 v182, v182, v9
    v_fma_f32 v34, v34, v8, v182
    v_mul_f32 v183, v183, v9
    v_fma_f32 v35, v35, v8, v183
    v_mul_f32 v184, v184, v9
    v_fma_f32 v36, v36, v8, v184
    v_mul_f32 v185, v185, v9
    v_fma_f32 v37, v37, v8, v185
    v_mul_f32 v186, v186, v9
    v_fma_f32 v38, v38, v8, v186
    v_mul_f32 v187, v187, v9
    v_fma_f32 v39, v39, v8, v187
    v_mul_f32 v188, v188, v9
    v_fma_f32 v40, v40, v8, v188
    v_mul_f32 v189, v189, v9
    v_fma_f32 v41, v41, v8, v189
    v_mul_f32 v190, v190, v9
    v_fma_f32 v42, v42, v8, v190
    v_mul_f32 v191, v191, v9
    v_fma_f32 v43, v43, v8, v191
    v_mul_f32 v192, v192, v9
    v_fma_f32 v44, v44, v8, v192
    v_mul_f32 v193, v193, v9
    v_fma_f32 v45, v45, v8, v193
    v_mul_f32 v194, v194, v9
    v_fma_f32 v46, v46, v8, v194
    v_mul_f32 v195, v195, v9
    v_fma_f32 v47, v47, v8, v195
    v_cvt_pk_bf16_f32 v32, v32, v33
    v_cvt_pk_bf16_f32 v33, v34, v35
    v_cvt_pk_bf16_f32 v34, v36, v37
    v_cvt_pk_bf16_f32 v35, v38, v39
    v_cvt_pk_bf16_f32 v36, v40, v41
    v_cvt_pk_bf16_f32 v37, v42, v43
    v_cvt_pk_bf16_f32 v38, v44, v45
    v_cvt_pk_bf16_f32 v39, v46, v47
    s_add_u32 s49, s3, 0x200000
    s_add_u32 s50, s3, 0x210000
    buffer_store_dwordx4 v[32:35], v1, s[24:27], s49 offen sc1
    buffer_store_dwordx4 v[36:39], v1, s[24:27], s50 offen sc1
    v_mul_f32 v8, 0x3eb8aa3b, v8
    v_mul_f32 v9, 0x3eb8aa3b, v9
    s_waitcnt lgkmcnt(0)
    v_mul_f32 v164, v164, v9
    v_fma_f32 v16, v16, v8, v164
    v_mul_f32 v165, v165, v9
    v_fma_f32 v17, v17, v8, v165
    v_mul_f32 v166, v166, v9
    v_fma_f32 v18, v18, v8, v166
    v_mul_f32 v167, v167, v9
    v_fma_f32 v19, v19, v8, v167
    v_mul_f32 v168, v168, v9
    v_fma_f32 v20, v20, v8, v168
    v_mul_f32 v169, v169, v9
    v_fma_f32 v21, v21, v8, v169
    v_mul_f32 v170, v170, v9
    v_fma_f32 v22, v22, v8, v170
    v_mul_f32 v171, v171, v9
    v_fma_f32 v23, v23, v8, v171
    v_mul_f32 v172, v172, v9
    v_fma_f32 v24, v24, v8, v172
    v_mul_f32 v173, v173, v9
    v_fma_f32 v25, v25, v8, v173
    v_mul_f32 v174, v174, v9
    v_fma_f32 v26, v26, v8, v174
    v_mul_f32 v175, v175, v9
    v_fma_f32 v27, v27, v8, v175
    v_mul_f32 v176, v176, v9
    v_fma_f32 v28, v28, v8, v176
    v_mul_f32 v177, v177, v9
    v_fma_f32 v29, v29, v8, v177
    v_mul_f32 v178, v178, v9
    v_fma_f32 v30, v30, v8, v178
    v_mul_f32 v179, v179, v9
    v_fma_f32 v31, v31, v8, v179
    v_cvt_pk_bf16_f32 v16, v16, v17
    v_cvt_pk_bf16_f32 v17, v18, v19
    v_cvt_pk_bf16_f32 v18, v20, v21
    v_cvt_pk_bf16_f32 v19, v22, v23
    v_cvt_pk_bf16_f32 v20, v24, v25
    v_cvt_pk_bf16_f32 v21, v26, v27
    v_cvt_pk_bf16_f32 v22, v28, v29
    v_cvt_pk_bf16_f32 v23, v30, v31
    s_add_u32 s50, s3, 0x10000
    buffer_store_dwordx4 v[16:19], v1, s[24:27], s3 offen sc1
    buffer_store_dwordx4 v[20:23], v1, s[24:27], s50 offen sc1
    s_waitcnt vmcnt(0)
    s_branch L_p1join
L_help:
    s_cmp_ge_u32 s22, 6
    s_cbranch_scc1 L_helpx
    s_waitcnt vmcnt(12)
    s_barrier
    s_add_u32 s69, s67, 2
    s_and_b32 s69, s69, 7
    s_mul_i32 s69, s69, 196608
    s_add_u32 m0, s66, 49152
    s_add_u32 s69, s69, s64
    buffer_load_dwordx4 v4, s[36:39], s69 offen offset:0 lds
    buffer_load_dwordx4 v4, s[36:39], s69 offen offset:1024 lds
    buffer_load_dwordx4 v4, s[36:39], s69 offen offset:2048 lds
    s_add_u32 m0, s66, 52224
    s_nop 0
    buffer_load_dwordx4 v5, s[36:39], s69 offen offset:0 lds
    buffer_load_dwordx4 v5, s[36:39], s69 offen offset:1024 lds
    buffer_load_dwordx4 v5, s[36:39], s69 offen offset:2048 lds
    s_add_u32 m0, s66, 55296
    s_add_u32 s69, s69, 49152
    buffer_load_dwordx4 v4, s[36:39], s69 offen offset:0 lds
    buffer_load_dwordx4 v4, s[36:39], s69 offen offset:1024 lds
    buffer_load_dwordx4 v4, s[36:39], s69 offen offset:2048 lds
    s_add_u32 m0, s66, 58368
    s_nop 0
    buffer_load_dwordx4 v5, s[36:39], s69 offen offset:0 lds
    buffer_load_dwordx4 v5, s[36:39], s69 offen offset:1024 lds
    buffer_load_dwordx4 v5, s[36:39], s69 offen offset:2048 lds
    s_waitcnt vmcnt(12)
    s_barrier
    s_add_u32 s69, s67, 3
    s_and_b32 s69, s69, 7
    s_mul_i32 s69, s69, 196608
    s_add_u32 m0, s66, 73728
    s_add_u32 s69, s69, s64
    buffer_load_dwordx4 v4, s[36:39], s69 offen offset:0 lds
    buffer_load_dwordx4 v4, s[36:39], s69 offen offset:1024 lds
    buffer_load_dwordx4 v4, s[36:39], s69 offen offset:2048 lds
    s_add_u32 m0, s66, 76800
    s_nop 0
    buffer_load_dwordx4 v5, s[36:39], s69 offen offset:0 lds
    buffer_load_dwordx4 v5, s[36:39], s69 offen offset:1024 lds
    buffer_load_dwordx4 v5, s[36:39], s69 offen offset:2048 lds
    s_add_u32 m0, s66, 79872
    s_add_u32 s69, s69, 49152
    buffer_load_dwordx4 v4, s[36:39], s69 offen offset:0 lds
    buffer_load_dwordx4 v4, s[36:39], s69 offen offset:1024 lds
    buffer_load_dwordx4 v4, s[36:39], s69 offen offset:2048 lds
    s_add_u32 m0, s66, 82944
    s_nop 0
    buffer_load_dwordx4 v5, s[36:39], s69 offen offset:0 lds
    buffer_load_dwordx4 v5, s[36:39], s69 offen offset:1024 lds
    buffer_load_dwordx4 v5, s[36:39], s69 offen offset:2048 lds
    s_waitcnt vmcnt(12)
    s_barrier
    s_add_u32 s69, s67, 4
    s_and_b32 s69, s69, 7
    s_mul_i32 s69, s69, 196608
    s_add_u32 m0, s66, 0
    s_add_u32 s69, s69, s64
    buffer_load_dwordx4 v4, s[36:39], s69 offen offset:0 lds
    buffer_load_dwordx4 v4, s[36:39], s69 offen offset:1024 lds
    buffer_load_dwordx4 v4, s[36:39], s69 offen offset:2048 lds
    s_add_u32 m0, s66, 3072
    s_nop 0
    buffer_load_dwordx4 v5, s[36:39], s69 offen offset:0 lds
    buffer_load_dwordx4 v5, s[36:39], s69 offen offset:1024 lds
    buffer_load_dwordx4 v5, s[36:39], s69 offen offset:2048 lds
    s_add_u32 m0, s66, 6144
    s_add_u32 s69, s69, 49152
    buffer_load_dwordx4 v4, s[36:39], s69 offen offset:0 lds
    buffer_load_dwordx4 v4, s[36:39], s69 offen offset:1024 lds
    buffer_load_dwordx4 v4, s[36:39], s69 offen offset:2048 lds
    s_add_u32 m0, s66, 9216
    s_nop 0
    buffer_load_dwordx4 v5, s[36:39], s69 offen offset:0 lds
    buffer_load_dwordx4 v5, s[36:39], s69 offen offset:1024 lds
    buffer_load_dwordx4 v5, s[36:39], s69 offen offset:2048 lds
    s_waitcnt vmcnt(12)
    s_barrier
    s_add_u32 s69, s67, 5
    s_and_b32 s69, s69, 7
    s_mul_i32 s69, s69, 196608
    s_add_u32 m0, s66, 24576
    s_add_u32 s69, s69, s64
    buffer_load_dwordx4 v4, s[36:39], s69 offen offset:0 lds
    buffer_load_dwordx4 v4, s[36:39], s69 offen offset:1024 lds
    buffer_load_dwordx4 v4, s[36:39], s69 offen offset:2048 lds
    s_add_u32 m0, s66, 27648
    s_nop 0
    buffer_load_dwordx4 v5, s[36:39], s69 offen offset:0 lds
    buffer_load_dwordx4 v5, s[36:39], s69 offen offset:1024 lds
    buffer_load_dwordx4 v5, s[36:39], s69 offen offset:2048 lds
    s_add_u32 m0, s66, 30720
    s_add_u32 s69, s69, 49152
    buffer_load_dwordx4 v4, s[36:39], s69 offen offset:0 lds
    buffer_load_dwordx4 v4, s[36:39], s69 offen offset:1024 lds
    buffer_load_dwordx4 v4, s[36:39], s69 offen offset:2048 lds
    s_add_u32 m0, s66, 33792
    s_nop 0
    buffer_load_dwordx4 v5, s[36:39], s69 offen offset:0 lds
    buffer_load_dwordx4 v5, s[36:39], s69 offen offset:1024 lds
    buffer_load_dwordx4 v5, s[36:39], s69 offen offset:2048 lds
    s_waitcnt vmcnt(12)
    s_barrier
    s_add_u32 s69, s67, 6
    s_and_b32 s69, s69, 7
    s_mul_i32 s69, s69, 196608
    s_add_u32 m0, s66, 49152
    s_add_u32 s69, s69, s64
    buffer_load_dwordx4 v4, s[36:39], s69 offen offset:0 lds
    buffer_load_dwordx4 v4, s[36:39], s69 offen offset:1024 lds
    buffer_load_dwordx4 v4, s[36:39], s69 offen offset:2048 lds
    s_add_u32 m0, s66, 52224
    s_nop 0
    buffer_load_dwordx4 v5, s[36:39], s69 offen offset:0 lds
    buffer_load_dwordx4 v5, s[36:39], s69 offen offset:1024 lds
    buffer_load_dwordx4 v5, s[36:39], s69 offen offset:2048 lds
    s_add_u32 m0, s66, 55296
    s_add_u32 s69, s69, 49152
    buffer_load_dwordx4 v4, s[36:39], s69 offen offset:0 lds
    buffer_load_dwordx4 v4, s[36:39], s69 offen offset:1024 lds
    buffer_load_dwordx4 v4, s[36:39], s69 offen offset:2048 lds
    s_add_u32 m0, s66, 58368
    s_nop 0
    buffer_load_dwordx4 v5, s[36:39], s69 offen offset:0 lds
    buffer_load_dwordx4 v5, s[36:39], s69 offen offset:1024 lds
    buffer_load_dwordx4 v5, s[36:39], s69 offen offset:2048 lds
    s_waitcnt vmcnt(12)
    s_barrier
    s_add_u32 s69, s67, 7
    s_and_b32 s69, s69, 7
    s_mul_i32 s69, s69, 196608
    s_add_u32 m0, s66, 73728
    s_add_u32 s69, s69, s64
    buffer_load_dwordx4 v4, s[36:39], s69 offen offset:0 lds
    buffer_load_dwordx4 v4, s[36:39], s69 offen offset:1024 lds
    buffer_load_dwordx4 v4, s[36:39], s69 offen offset:2048 lds
    s_add_u32 m0, s66, 76800
    s_nop 0
    buffer_load_dwordx4 v5, s[36:39], s69 offen offset:0 lds
    buffer_load_dwordx4 v5, s[36:39], s69 offen offset:1024 lds
    buffer_load_dwordx4 v5, s[36:39], s69 offen offset:2048 lds
    s_add_u32 m0, s66, 79872
    s_add_u32 s69, s69, 49152
    buffer_load_dwordx4 v4, s[36:39], s69 offen offset:0 lds
    buffer_load_dwordx4 v4, s[36:39], s69 offen offset:1024 lds
    buffer_load_dwordx4 v4, s[36:39], s69 offen offset:2048 lds
    s_add_u32 m0, s66, 82944
    s_nop 0
    buffer_load_dwordx4 v5, s[36:39], s69 offen offset:0 lds
    buffer_load_dwordx4 v5, s[36:39], s69 offen offset:1024 lds
    buffer_load_dwordx4 v5, s[36:39], s69 offen offset:2048 lds
    s_waitcnt vmcnt(12)
    s_barrier
    buffer_load_dwordx2 v[84:85], v6, s[44:47], 0 offen sc1
    s_waitcnt vmcnt(1)
    s_barrier
    s_barrier
    buffer_load_dwordx2 v[86:87], v6, s[44:47], 0 offen sc1
    ds_read_b32 v11, v6 offset:640
    s_waitcnt vmcnt(0) lgkmcnt(0)
    v_mov_b32 v84, v86
    v_mov_b32 v85, v87
    v_readfirstlane_b32 s70, v11
    s_branch L_p1join
L_helpx:
    v_and_b32 v11, 31, v10
    v_lshlrev_b32 v14, 4, v11
    v_lshrrev_b32 v12, 5, v10
    v_lshl_add_u32 v13, v12, 11, v14
    v_lshlrev_b32 v11, 2, v11
    s_and_b32 s49, s23, 1
    s_lshl_b32 s48, s49, 11
    v_add_u32 v11, s48, v11
    s_lshl_b32 s56, s60, 13
    s_add_u32 s56, s56, 0x1680000
    s_add_u32 s64, s56, 4096
    s_lshl_b32 s48, s73, 1
    s_add_u32 s48, s48, s49
    s_lshl_b32 s48, s48, 5
    s_and_b32 s49, s60, 24
    s_add_u32 s48, s48, s49
    s_lshl_b32 s57, s48, 9
    s_add_u32 s57, s57, 0x1700000
    s_and_b32 s50, s2, 7
    s_lshl_b32 s50, s50, 9
    s_add_u32 s50, s50, 0x17b8000
    s_waitcnt vmcnt(4)
    s_barrier
    s_add_u32 s68, s67, 2
    s_and_b32 s68, s68, 7
    s_lshl_b32 s68, s68, 7
    s_add_u32 m0, s65, 16384
    s_add_u32 s68, s68, s63
    buffer_load_dwordx4 v2, s[28:31], s68 offen offset:0 lds
    buffer_load_dwordx4 v3, s[28:31], s68 offen offset:1024 lds
    buffer_load_dwordx4 v8, s[28:31], s68 offen offset:2048 lds
    buffer_load_dwordx4 v9, s[28:31], s68 offen offset:3072 lds
    s_add_u32 s68, s67, 3
    s_and_b32 s68, s68, 7
    s_lshl_b32 s68, s68, 7
    s_add_u32 m0, s65, 24576
    s_add_u32 s68, s68, s63
    buffer_load_dwordx4 v2, s[28:31], s68 offen offset:0 lds
    buffer_load_dwordx4 v3, s[28:31], s68 offen offset:1024 lds
    buffer_load_dwordx4 v8, s[28:31], s68 offen offset:2048 lds
    buffer_load_dwordx4 v9, s[28:31], s68 offen offset:3072 lds
    s_waitcnt vmcnt(8)
    s_barrier
    s_add_u32 s68, s67, 4
    s_and_b32 s68, s68, 7
    s_lshl_b32 s68, s68, 7
    s_add_u32 m0, s65, 32768
    s_add_u32 s68, s68, s63
    buffer_load_dwordx4 v2, s[28:31], s68 offen offset:0 lds
    buffer_load_dwordx4 v3, s[28:31], s68 offen offset:1024 lds
    buffer_load_dwordx4 v8, s[28:31], s68 offen offset:2048 lds
    buffer_load_dwordx4 v9, s[28:31], s68 offen offset:3072 lds
    s_add_u32 s68, s67, 5
    s_and_b32 s68, s68, 7
    s_lshl_b32 s68, s68, 7
    s_add_u32 m0, s65, 40960
    s_add_u32 s68, s68, s63
    buffer_load_dwordx4 v2, s[28:31], s68 offen offset:0 lds
    buffer_load_dwordx4 v3, s[28:31], s68 offen offset:1024 lds
    buffer_load_dwordx4 v8, s[28:31], s68 offen offset:2048 lds
    buffer_load_dwordx4 v9, s[28:31], s68 offen offset:3072 lds
    s_waitcnt vmcnt(12)
    s_barrier
    s_add_u32 s68, s67, 6
    s_and_b32 s68, s68, 7
    s_lshl_b32 s68, s68, 7
    s_add_u32 m0, s65, 49152
    s_add_u32 s68, s68, s63
    buffer_load_dwordx4 v2, s[28:31], s68 offen offset:0 lds
    buffer_load_dwordx4 v3, s[28:31], s68 offen offset:1024 lds
    buffer_load_dwordx4 v8, s[28:31], s68 offen offset:2048 lds
    buffer_load_dwordx4 v9, s[28:31], s68 offen offset:3072 lds
    s_add_u32 s68, s67, 7
    s_and_b32 s68, s68, 7
    s_lshl_b32 s68, s68, 7
    s_add_u32 m0, s65, 57344
    s_add_u32 s68, s68, s63
    buffer_load_dwordx4 v2, s[28:31], s68 offen offset:0 lds
    buffer_load_dwordx4 v3, s[28:31], s68 offen offset:1024 lds
    buffer_load_dwordx4 v8, s[28:31], s68 offen offset:2048 lds
    buffer_load_dwordx4 v9, s[28:31], s68 offen offset:3072 lds
    s_waitcnt vmcnt(16)
    s_barrier
    s_waitcnt vmcnt(12)
    s_barrier
    s_waitcnt vmcnt(8)
    s_barrier
    buffer_load_dwordx2 v[84:85], v6, s[44:47], 0 offen sc1
    buffer_load_dwordx4 v[64:67], v14, s[24:27], s50 offen sc1
    buffer_load_dwordx4 v[16:19], v13, s[24:27], s56 offen sc1
    buffer_load_dwordx4 v[20:23], v13, s[24:27], s56 offen offset:512 sc1
    buffer_load_dwordx4 v[24:27], v13, s[24:27], s56 offen offset:1024 sc1
    buffer_load_dwordx4 v[28:31], v13, s[24:27], s56 offen offset:1536 sc1
    buffer_load_dwordx4 v[32:35], v13, s[24:27], s64 offen sc1
    buffer_load_dwordx4 v[36:39], v13, s[24:27], s64 offen offset:512 sc1
    buffer_load_dwordx4 v[40:43], v13, s[24:27], s64 offen offset:1024 sc1
    buffer_load_dwordx4 v[44:47], v13, s[24:27], s64 offen offset:1536 sc1
    buffer_load_dwordx4 v[48:51], v13, s[24:27], s57 offen sc1
    buffer_load_dwordx4 v[52:55], v13, s[24:27], s57 offen offset:512 sc1
    buffer_load_dwordx4 v[56:59], v13, s[24:27], s57 offen offset:1024 sc1
    buffer_load_dwordx4 v[60:63], v13, s[24:27], s57 offen offset:1536 sc1
    s_waitcnt vmcnt(18)
    s_barrier
    s_waitcnt vmcnt(14)
    s_barrier
    s_mov_b32 s51, 0
L_gchk:
    s_waitcnt vmcnt(0)
    v_cmp_ne_u32 vcc, 0, v85
    v_cmp_eq_u64 s[52:53], v[64:65], v[84:85]
    s_and_b64 vcc, vcc, s[52:53]
    v_cmp_eq_u64 s[52:53], v[18:19], v[84:85]
    s_and_b64 vcc, vcc, s[52:53]
    v_cmp_eq_u64 s[52:53], v[34:35], v[84:85]
    s_and_b64 vcc, vcc, s[52:53]
    v_cmp_eq_u32 s[52:53], v51, v84
    s_and_b64 vcc, vcc, s[52:53]
    v_cmp_eq_u64 s[52:53], v[22:23], v[84:85]
    s_and_b64 vcc, vcc, s[52:53]
    v_cmp_eq_u64 s[52:53], v[38:39], v[84:85]
    s_and_b64 vcc, vcc, s[52:53]
    v_cmp_eq_u32 s[52:53], v55, v84
    s_and_b64 vcc, vcc, s[52:53]
    v_cmp_eq_u64 s[52:53], v[26:27], v[84:85]
    s_and_b64 vcc, vcc, s[52:53]
    v_cmp_eq_u64 s[52:53], v[42:43], v[84:85]
    s_and_b64 vcc, vcc, s[52:53]
    v_cmp_eq_u32 s[52:53], v59, v84
    s_and_b64 vcc, vcc, s[52:53]
    v_cmp_eq_u64 s[52:53], v[30:31], v[84:85]
    s_and_b64 vcc, vcc, s[52:53]
    v_cmp_eq_u64 s[52:53], v[46:47], v[84:85]
    s_and_b64 vcc, vcc, s[52:53]
    v_cmp_eq_u32 s[52:53], v63, v84
    s_and_b64 vcc, vcc, s[52:53]
    s_cmp_eq_u64 vcc, -1
    s_cbranch_scc1 L_gok
    s_add_u32 s51, s51, 1
    s_cmp_gt_u32 s51, 400000
    s_cbranch_scc1 L_gok
    buffer_load_dwordx2 v[84:85], v6, s[44:47], 0 offen sc1
    buffer_load_dwordx4 v[64:67], v14, s[24:27], s50 offen sc1
    buffer_load_dwordx4 v[16:19], v13, s[24:27], s56 offen sc1
    buffer_load_dwordx4 v[20:23], v13, s[24:27], s56 offen offset:512 sc1
    buffer_load_dwordx4 v[24:27], v13, s[24:27], s56 offen offset:1024 sc1
    buffer_load_dwordx4 v[28:31], v13, s[24:27], s56 offen offset:1536 sc1
    buffer_load_dwordx4 v[32:35], v13, s[24:27], s64 offen sc1
    buffer_load_dwordx4 v[36:39], v13, s[24:27], s64 offen offset:512 sc1
    buffer_load_dwordx4 v[40:43], v13, s[24:27], s64 offen offset:1024 sc1
    buffer_load_dwordx4 v[44:47], v13, s[24:27], s64 offen offset:1536 sc1
    buffer_load_dwordx4 v[48:51], v13, s[24:27], s57 offen sc1
    buffer_load_dwordx4 v[52:55], v13, s[24:27], s57 offen offset:512 sc1
    buffer_load_dwordx4 v[56:59], v13, s[24:27], s57 offen offset:1024 sc1
    buffer_load_dwordx4 v[60:63], v13, s[24:27], s57 offen offset:1536 sc1
    s_branch L_gchk
L_gok:
    s_waitcnt vmcnt(0)
    v_cmp_eq_u32 vcc, s21, v66
    v_add_f32 v16, v16, v20
    v_add_f32 v24, v24, v28
    v_add_f32 v17, v17, v21
    v_add_f32 v25, v25, v29
    v_add_f32 v32, v32, v36
    v_add_f32 v40, v40, v44
    v_add_f32 v33, v33, v37
    v_add_f32 v41, v41, v45
    v_add_f32 v48, v48, v52
    v_add_f32 v56, v56, v60
    v_add_f32 v49, v49, v53
    v_add_f32 v57, v57, v61
    v_add_f32 v50, v50, v54
    v_add_f32 v58, v58, v62
    s_cmp_eq_u64 vcc, -1
    s_cselect_b32 s70, 1, 0
    v_add_f32 v16, v16, v24
    v_add_f32 v17, v17, v25
    v_add_f32 v32, v32, v40
    v_add_f32 v33, v33, v41
    v_add_f32 v48, v48, v56
    v_add_f32 v49, v49, v57
    v_add_f32 v50, v50, v58
    v_mov_b32 v20, v16
    v_mov_b32 v21, v17
    v_mov_b32 v36, v32
    v_mov_b32 v37, v33
    v_mov_b32 v52, v48
    v_mov_b32 v53, v49
    v_mov_b32 v54, v50
    v_mov_b32 v64, s70
    s_nop 0
    v_permlane32_swap_b32 v16, v20
    v_permlane32_swap_b32 v17, v21
    v_permlane32_swap_b32 v32, v36
    v_permlane32_swap_b32 v33, v37
    v_permlane32_swap_b32 v48, v52
    v_permlane32_swap_b32 v49, v53
    v_permlane32_swap_b32 v50, v54
    v_add_f32 v16, v16, v20
    v_add_f32 v17, v17, v21
    v_add_f32 v32, v32, v36
    v_add_f32 v33, v33, v37
    v_add_f32 v48, v48, v52
    v_add_f32 v49, v49, v53
    v_add_f32 v50, v50, v54
    v_mul_f32 v16, 0x3b000000, v16
    v_mul_f32 v17, 0x3b000000, v17
    v_fma_f32 v17, -v16, v16, v17
    v_max_f32 v17, 0, v17
    v_add_f32 v17, 0x3727c5ac, v17
    v_rsq_f32 v17, v17
    ds_write_b32 v11, v48 offset:256
    ds_write_b32 v11, v49 offset:384
    ds_write_b32 v11, v50 offset:512
    ds_write_b32 v11, v64 offset:640
    v_mul_f32 v16, v16, v17
    v_sub_f32 v16, 0, v16
    ds_write_b32 v11, v17 offset:0
    ds_write_b32 v11, v16 offset:128
    v_mul_f32 v32, 0x3b000000, v32
    v_mul_f32 v33, 0x3b000000, v33
    v_fma_f32 v33, -v32, v32, v33
    v_max_f32 v33, 0, v33
    v_add_f32 v33, 0x3727c5ac, v33
    v_rsq_f32 v33, v33
    ds_write_b32 v11, v48 offset:1280
    ds_write_b32 v11, v49 offset:1408
    ds_write_b32 v11, v50 offset:1536
    ds_write_b32 v11, v64 offset:1664
    v_mul_f32 v32, v32, v33
    v_sub_f32 v32, 0, v32
    ds_write_b32 v11, v33 offset:1024
    ds_write_b32 v11, v32 offset:1152
    s_waitcnt lgkmcnt(0)
    s_barrier
L_p1join:
    s_setprio 0
    s_barrier
    v_mov_b32 v112, 0
    s_cmp_lt_u32 s22, 4
    s_cbranch_scc1 L_sideS
    v_lshrrev_b32 v11, 2, v10
    v_and_b32 v12, 3, v10
    s_cmp_ge_u32 s2, 112
    s_cbranch_scc1 L_sideB
    v_mul_u32_u24 v11, 3584, v11
    s_lshl_b32 s48, s2, 2
    s_add_u32 s48, s48, s23
    s_lshl_b32 s58, s48, 12
    s_add_u32 s58, s58, 0x700000
    s_and_b32 s59, s48, 7
    s_mul_i32 s59, s59, 229376
    s_lshr_b32 s49, s48, 3
    s_mov_b32 s64, 57344
    s_branch L_sideJ
L_sideB:
    v_lshlrev_b32 v11, 10, v11
    s_mov_b32 s64, 16384
    s_cmp_ge_u32 s2, 224
    s_cbranch_scc1 L_sideC
    s_mov_b32 s40, s14
    s_mov_b32 s41, s15
    s_mov_b32 s42, 0x1c0000
    s_mov_b32 s43, 0x00020000
    s_sub_u32 s48, s2, 112
    s_lshl_b32 s48, s48, 2
    s_add_u32 s48, s48, s23
    s_mul_i32 s49, s48, 2341
    s_lshr_b32 s49, s49, 16
    s_lshl_b32 s58, s48, 12
    s_add_u32 s58, s58, 0x900000
    s_mul_i32 s50, s49, 28
    s_sub_u32 s48, s48, s50
    s_lshl_b32 s59, s48, 16
    s_branch L_sideJ
L_sideC:
    s_mov_b32 s40, s8
    s_mov_b32 s41, s9
    s_mov_b32 s42, 0x80000
    s_mov_b32 s43, 0x00020000
    s_sub_u32 s48, s2, 224
    s_lshl_b32 s48, s48, 2
    s_add_u32 s48, s48, s23
    s_lshl_b32 s58, s48, 12
    s_add_u32 s58, s58, 0x600000
    s_and_b32 s59, s48, 7
    s_lshl_b32 s59, s59, 16
    s_lshr_b32 s49, s48, 3
L_sideJ:
    s_lshl_b32 s49, s49, 6
    s_add_u32 s59, s59, s49
    v_lshl_add_u32 v112, v12, 4, v11
L_sideS:
    s_and_b32 s48, s2, 7
    s_lshr_b32 s49, s2, 3
    s_lshl_b32 s6, s48, 2
    s_and_b32 s7, s49, 3
    s_add_u32 s6, s6, s7
    s_lshr_b32 s7, s2, 5
    s_and_b32 s4, s49, 7
    s_lshr_b32 s5, s49, 3
    s_lshl_b32 s48, s48, 2
    s_add_u32 s5, s5, s48
    v_mov_b32 v4, v84
    v_mov_b32 v5, v85
    s_cmp_lg_u32 s22, 0
    s_cbranch_scc1 L_w0_sequen_7
    s_lshl_b32 s48, s73, 5
    s_add_u32 s48, s48, s60
    s_lshl_b32 s48, s48, 7
    s_add_u32 s49, s48, 0x1780000
    v_lshrrev_b32 v6, 1, v1
    s_mov_b64 exec, 0xffff
    buffer_store_dwordx2 v[4:5], v6, s[24:27], s49 offen sc1
    s_mov_b64 exec, -1
    v_lshlrev_b32 v6, 3, v1
    s_and_b32 s48, s2, 7
    s_lshl_b32 s48, s48, 12
    s_add_u32 s48, s48, 0x1780000
    s_mov_b32 s69, s48
    s_lshl_b32 s49, s7, 2
    s_mov_b32 s56, 0xff
    s_mov_b32 s57, 0
    s_lshl_b64 s[56:57], s[56:57], s49
    s_or_b32 s49, s56, s57
    s_lshl_b32 s49, s7, 2
    s_lshl_b32 s49, 15, s49
    s_or_b32 s49, s49, 0xff
    s_mov_b32 s51, 0
    s_mov_b32 exec_hi, 0
    s_mov_b32 exec_lo, s49
L_poll_sequen_8:
    buffer_load_dwordx2 v[8:9], v6, s[24:27], s48 offen sc1
    s_add_u32 s51, s51, 1
    s_waitcnt vmcnt(0)
    v_cmp_eq_u64 vcc, v[8:9], v[4:5]
    s_cmp_gt_u32 s51, 400000
    s_cbranch_scc1 L_pdone_sequen_9
    s_cmp_eq_u64 vcc, exec
    s_cbranch_scc0 L_poll_sequen_8
L_pdone_sequen_9:
    s_mov_b64 exec, -1
L_w0_sequen_7:
    s_lshr_b32 s8, s22, 2
    s_bfe_u32 s9, s22, 0x10001
    s_and_b32 s10, s22, 1
    s_lshl_b32 s11, s6, 16
    s_lshl_b32 s12, s22, 10
    s_add_u32 s11, s11, s12
    s_mul_i32 s16, s4, 224
    s_mul_i32 s49, s22, 14
    s_add_u32 s16, s16, s49
    s_lshl_b32 s16, s16, 10
    s_add_u32 s16, s16, 0x900000
    s_mul_i32 s13, s4, 7
    s_add_u32 s13, s13, s22
    s_lshl_b32 s13, s13, 15
    s_add_u32 s13, s13, 0x700000
    s_cmp_eq_u32 s22, 7
    s_cselect_b32 s13, s16, s13
    s_cselect_b32 s14, 112, 1
    s_cselect_b32 s15, 1, 2
    s_lshl_b32 s14, s14, 10
    s_lshl_b32 s15, s15, 10
    s_add_u32 s14, s14, s13
    s_lshl_b32 s19, s22, 12
    s_lshl_b32 s20, s4, 16
    s_add_u32 s20, s20, s19
    s_add_u32 s20, s20, 0x600000
    v_lshrrev_b32 v11, 5, v10
    v_and_b32 v2, 15, v10
    v_lshlrev_b32 v11, 8, v11
    v_lshl_add_u32 v11, v2, 4, v11
    v_add_u32 v3, 65536, v11
    v_and_b32 v2, 31, v10
    v_cmp_eq_u32 vcc, 16, v2
    v_mov_b32 v11, 0x3f803f80
    v_lshlrev_b32 v2, 10, v2
    v_cndmask_b32 v11, 0, v11, vcc
    v_mov_b32 v24, v11
    v_mov_b32 v25, v11
    v_mov_b32 v26, v11
    v_mov_b32 v27, v11
    v_mov_b32 v28, v11
    v_mov_b32 v29, v11
    v_mov_b32 v30, v11
    v_mov_b32 v31, v11
    v_mov_b32 v32, v11
    v_mov_b32 v33, v11
    v_mov_b32 v34, v11
    v_mov_b32 v35, v11
    v_mov_b32 v36, v11
    v_mov_b32 v37, v11
    v_mov_b32 v38, v11
    v_mov_b32 v39, v11
    v_mov_b32 v40, 0
    v_mov_b32 v41, 0
    v_mov_b32 v42, 0
    v_mov_b32 v43, 0
    v_mov_b32 v44, 0
    v_mov_b32 v45, 0
    v_mov_b32 v46, 0
    v_mov_b32 v47, 0
    v_mov_b32 v48, 0
    v_mov_b32 v49, 0
    v_mov_b32 v50, 0
    v_mov_b32 v51, 0
    v_mov_b32 v52, 0
    v_mov_b32 v53, 0
    v_mov_b32 v54, 0
    v_mov_b32 v55, 0
    v_lshrrev_b32 v11, 5, v10
    v_lshl_add_u32 v7, v11, 3, v2
    s_lshl_b32 s50, s5, 1
    s_add_u32 s50, s50, s9
    s_lshl_b32 s17, s50, 15
    s_lshl_b32 s48, s4, 7
    s_add_u32 s17, s17, s48
    s_lshl_b32 s48, s8, 6
    s_add_u32 s17, s17, s48
    s_lshl_b32 s48, s10, 5
    s_add_u32 s17, s17, s48
    v_lshrrev_b32 v11, 5, v10
    v_bfe_u32 v2, v10, 2, 2
    v_lshl_add_u32 v11, v11, 2, v2
    v_lshlrev_b32 v11, 6, v11
    v_bfe_u32 v2, v10, 4, 1
    v_lshl_add_u32 v11, v2, 5, v11
    v_and_b32 v2, 3, v10
    v_lshl_add_u32 v11, v2, 3, v11
    s_lshl_b32 s48, s23, 12
    s_add_u32 s71, s48, 131072
    v_add_u32 v113, s71, v11
    s_mul_i32 s48, s5, 224
    s_mul_i32 s49, s4, 14
    s_add_u32 s48, s48, s49
    s_lshl_b32 s49, s22, 1
    s_add_u32 s48, s48, s49
    s_lshl_b32 s48, s48, 10
    s_add_u32 s60, s48, 0xf00000
    s_lshl_b32 s48, s50, 5
    s_lshl_b32 s49, s4, 2
    s_add_u32 s48, s48, s49
    s_lshl_b32 s49, s8, 1
    s_add_u32 s48, s48, s49
    s_add_u32 s48, s48, s10
    s_lshl_b32 s61, s48, 10
    s_add_u32 s61, s61, 0xd00000
    s_lshl_b32 s62, s48, 8
    s_add_u32 s62, s62, 0x1600000
    v_and_b32 v2, 15, v10
    v_lshlrev_b32 v2, 7, v2
    v_bfe_u32 v11, v10, 4, 1
    v_mul_u32_u24 v11, 114688, v11
    v_add3_u32 v114, v2, v11, s60
    v_add_u32 v115, s61, v2
    v_cmp_lt_u32 vcc, 31, v10
    s_sub_u32 s48, s62, 1024
    v_add_u32 v2, s48, v2
    v_cndmask_b32 v114, v114, v115, vcc
    v_cmp_lt_u32 vcc, 39, v10
    s_cmp_eq_u32 s22, 7
    s_cselect_b32 s63, 0, -1
    v_cndmask_b32 v114, v114, v2, vcc
    s_lshl_b32 s48, s7, 3
    s_add_u32 s48, s48, s22
    s_lshl_b32 s48, s48, 5
    s_add_u32 s48, s48, s6
    s_lshl_b32 s48, s48, 10
    s_add_u32 s65, s48, 0xb00000
    s_lshl_b32 s48, s7, 13
    s_add_u32 s48, s48, s11
    s_barrier
    buffer_load_dwordx4 v[12:15], v1, s[24:27], s48 offen sc1
    s_mov_b32 s72, 0
    s_add_u32 s50, s11, s72
    s_add_u32 m0, s12, 0
    s_add_u32 s49, s50, 0x200000
    buffer_load_dwordx4 v1, s[24:27], s49 offen sc1 lds
    s_add_u32 m0, s12, 65536
    s_add_u32 s49, s50, 0x400000
    buffer_load_dwordx4 v1, s[24:27], s49 offen sc1 lds
    s_add_u32 s72, s72, 8192
    s_and_b32 s72, s72, 0xffff
    s_add_u32 s50, s11, s72
    s_add_u32 m0, s12, 8192
    s_add_u32 s49, s50, 0x200000
    buffer_load_dwordx4 v1, s[24:27], s49 offen sc1 lds
    s_add_u32 m0, s12, 73728
    s_add_u32 s49, s50, 0x400000
    buffer_load_dwordx4 v1, s[24:27], s49 offen sc1 lds
    s_waitcnt vmcnt(2)
    s_barrier
    ds_read_b128 v[16:19], v1 offset:0
    ds_read_b128 v[20:23], v1 offset:1024
    s_mov_b64 exec, s[54:55]
    ds_read_b128 v[24:27], v3 offset:0
    ds_read_b128 v[28:31], v3 offset:512
    s_mov_b64 exec, -1
    s_waitcnt lgkmcnt(3)
    v_mfma_f32_32x32x16_bf16 v[72:87], v[16:19], v[12:15], 0
    s_nop 11
    v_max3_f32 v2, v72, v73, v74
    v_max3_f32 v2, v2, v75, v76
    v_max3_f32 v2, v2, v77, v78
    v_max3_f32 v2, v2, v79, v80
    v_max3_f32 v2, v2, v81, v82
    v_max3_f32 v2, v2, v83, v84
    v_max3_f32 v2, v2, v85, v86
    v_max_f32 v2, v2, v87
    v_mov_b32 v6, v2
    s_nop 1
    v_permlane32_swap_b32 v6, v2
    v_max_f32 v6, v6, v2
    v_sub_f32 v56, 0, v6
    v_sub_f32 v57, 0, v6
    v_sub_f32 v58, 0, v6
    v_sub_f32 v59, 0, v6
    v_sub_f32 v60, 0, v6
    v_sub_f32 v61, 0, v6
    v_sub_f32 v62, 0, v6
    v_sub_f32 v63, 0, v6
    v_sub_f32 v64, 0, v6
    v_sub_f32 v65, 0, v6
    v_sub_f32 v66, 0, v6
    v_sub_f32 v67, 0, v6
    v_sub_f32 v68, 0, v6
    v_sub_f32 v69, 0, v6
    v_sub_f32 v70, 0, v6
    v_sub_f32 v71, 0, v6
    s_nop 1
    v_mfma_f32_32x32x16_bf16 v[72:87], v[16:19], v[12:15], v[56:71]
    ds_read_b128 v[16:19], v1 offset:2048
    s_nop 10
    s_setprio 3
    v_exp_f32 v72, v72
    v_exp_f32 v73, v73
    s_mov_b64 exec, s[54:55]
    ds_read_b128 v[32:35], v3 offset:1024
    ds_read_b128 v[36:39], v3 offset:1536
    s_mov_b64 exec, -1
    v_exp_f32 v74, v74
    v_exp_f32 v75, v75
    v_exp_f32 v76, v76
    v_exp_f32 v77, v77
    v_exp_f32 v78, v78
    s_waitcnt lgkmcnt(3)
    v_mfma_f32_32x32x16_bf16 v[88:103], v[20:23], v[12:15], v[56:71]
    ds_read_b128 v[20:23], v1 offset:3072
    v_exp_f32 v79, v79
    v_cvt_pk_bf16_f32 v72, v72, v73
    v_cvt_pk_bf16_f32 v73, v74, v75
    v_cvt_pk_bf16_f32 v74, v76, v77
    v_cvt_pk_bf16_f32 v75, v78, v79
    v_exp_f32 v80, v80
    v_exp_f32 v81, v81
    v_mfma_f32_32x32x16_bf16 v[40:55], v[24:27], v[72:75], v[40:55]
    v_exp_f32 v82, v82
    v_exp_f32 v83, v83
    v_exp_f32 v84, v84
    v_exp_f32 v85, v85
    v_exp_f32 v86, v86
    v_exp_f32 v87, v87
    v_cvt_pk_bf16_f32 v80, v80, v81
    v_cvt_pk_bf16_f32 v81, v82, v83
    v_cvt_pk_bf16_f32 v82, v84, v85
    v_cvt_pk_bf16_f32 v83, v86, v87
    v_exp_f32 v88, v88
    v_exp_f32 v89, v89
    v_mfma_f32_32x32x16_bf16 v[40:55], v[28:31], v[80:83], v[40:55]
    s_mov_b64 exec, s[54:55]
    ds_read_b128 v[24:27], v3 offset:2048
    ds_read_b128 v[28:31], v3 offset:2560
    s_mov_b64 exec, -1
    v_exp_f32 v90, v90
    v_exp_f32 v91, v91
    v_exp_f32 v92, v92
    v_exp_f32 v93, v93
    v_exp_f32 v94, v94
    s_waitcnt lgkmcnt(3)
    v_mfma_f32_32x32x16_bf16 v[72:87], v[16:19], v[12:15], v[56:71]
    ds_read_b128 v[16:19], v1 offset:4096
    v_exp_f32 v95, v95
    v_cvt_pk_bf16_f32 v88, v88, v89
    v_cvt_pk_bf16_f32 v89, v90, v91
    v_cvt_pk_bf16_f32 v90, v92, v93
    v_cvt_pk_bf16_f32 v91, v94, v95
    v_exp_f32 v96, v96
    v_exp_f32 v97, v97
    v_mfma_f32_32x32x16_bf16 v[40:55], v[32:35], v[88:91], v[40:55]
    v_exp_f32 v98, v98
    v_exp_f32 v99, v99
    v_exp_f32 v100, v100
    v_exp_f32 v101, v101
    v_exp_f32 v102, v102
    v_exp_f32 v103, v103
    v_cvt_pk_bf16_f32 v96, v96, v97
    v_cvt_pk_bf16_f32 v97, v98, v99
    v_cvt_pk_bf16_f32 v98, v100, v101
    v_cvt_pk_bf16_f32 v99, v102, v103
    v_exp_f32 v72, v72
    v_exp_f32 v73, v73
    v_mfma_f32_32x32x16_bf16 v[40:55], v[36:39], v[96:99], v[40:55]
    s_mov_b64 exec, s[54:55]
    ds_read_b128 v[32:35], v3 offset:3072
    ds_read_b128 v[36:39], v3 offset:3584
    s_mov_b64 exec, -1
    v_exp_f32 v74, v74
    v_exp_f32 v75, v75
    v_exp_f32 v76, v76
    v_exp_f32 v77, v77
    v_exp_f32 v78, v78
    s_waitcnt lgkmcnt(3)
    v_mfma_f32_32x32x16_bf16 v[88:103], v[20:23], v[12:15], v[56:71]
    ds_read_b128 v[20:23], v1 offset:5120
    v_exp_f32 v79, v79
    v_cvt_pk_bf16_f32 v72, v72, v73
    v_cvt_pk_bf16_f32 v73, v74, v75
    v_cvt_pk_bf16_f32 v74, v76, v77
    v_cvt_pk_bf16_f32 v75, v78, v79
    v_exp_f32 v80, v80
    v_exp_f32 v81, v81
    v_mfma_f32_32x32x16_bf16 v[40:55], v[24:27], v[72:75], v[40:55]
    v_exp_f32 v82, v82
    v_exp_f32 v83, v83
    v_exp_f32 v84, v84
    v_exp_f32 v85, v85
    v_exp_f32 v86, v86
    v_exp_f32 v87, v87
    v_cvt_pk_bf16_f32 v80, v80, v81
    v_cvt_pk_bf16_f32 v81, v82, v83
    v_cvt_pk_bf16_f32 v82, v84, v85
    v_cvt_pk_bf16_f32 v83, v86, v87
    s_setprio 2
    v_exp_f32 v88, v88
    v_exp_f32 v89, v89
    v_mfma_f32_32x32x16_bf16 v[40:55], v[28:31], v[80:83], v[40:55]
    s_mov_b64 exec, s[54:55]
    ds_read_b128 v[24:27], v3 offset:4096
    ds_read_b128 v[28:31], v3 offset:4608
    s_mov_b64 exec, -1
    v_exp_f32 v90, v90
    v_exp_f32 v91, v91
    v_exp_f32 v92, v92
    v_exp_f32 v93, v93
    v_exp_f32 v94, v94
    s_waitcnt lgkmcnt(3)
    v_mfma_f32_32x32x16_bf16 v[72:87], v[16:19], v[12:15], v[56:71]
    ds_read_b128 v[16:19], v1 offset:6144
    v_exp_f32 v95, v95
    v_cvt_pk_bf16_f32 v88, v88, v89
    v_cvt_pk_bf16_f32 v89, v90, v91
    v_cvt_pk_bf16_f32 v90, v92, v93
    v_cvt_pk_bf16_f32 v91, v94, v95
    v_exp_f32 v96, v96
    v_exp_f32 v97, v97
    v_mfma_f32_32x32x16_bf16 v[40:55], v[32:35], v[88:91], v[40:55]
    v_exp_f32 v98, v98
    v_exp_f32 v99, v99
    v_exp_f32 v100, v100
    v_exp_f32 v101, v101
    v_exp_f32 v102, v102
    v_exp_f32 v103, v103
    v_cvt_pk_bf16_f32 v96, v96, v97
    v_cvt_pk_bf16_f32 v97, v98, v99
    v_cvt_pk_bf16_f32 v98, v100, v101
    v_cvt_pk_bf16_f32 v99, v102, v103
    s_setprio 0
    v_exp_f32 v72, v72
    v_exp_f32 v73, v73
    v_mfma_f32_32x32x16_bf16 v[40:55], v[36:39], v[96:99], v[40:55]
    s_mov_b64 exec, s[54:55]
    ds_read_b128 v[32:35], v3 offset:5120
    ds_read_b128 v[36:39], v3 offset:5632
    s_mov_b64 exec, -1
    v_exp_f32 v74, v74
    v_exp_f32 v75, v75
    v_exp_f32 v76, v76
    v_exp_f32 v77, v77
    v_exp_f32 v78, v78
    s_waitcnt lgkmcnt(3)
    v_mfma_f32_32x32x16_bf16 v[88:103], v[20:23], v[12:15], v[56:71]
    ds_read_b128 v[20:23], v1 offset:7168
    v_exp_f32 v79, v79
    v_cvt_pk_bf16_f32 v72, v72, v73
    v_cvt_pk_bf16_f32 v73, v74, v75
    v_cvt_pk_bf16_f32 v74, v76, v77
    v_cvt_pk_bf16_f32 v75, v78, v79
    v_exp_f32 v80, v80
    v_exp_f32 v81, v81
    v_mfma_f32_32x32x16_bf16 v[40:55], v[24:27], v[72:75], v[40:55]
    v_exp_f32 v82, v82
    v_exp_f32 v83, v83
    v_exp_f32 v84, v84
    v_exp_f32 v85, v85
    v_exp_f32 v86, v86
    v_exp_f32 v87, v87
    v_cvt_pk_bf16_f32 v80, v80, v81
    v_cvt_pk_bf16_f32 v81, v82, v83
    v_cvt_pk_bf16_f32 v82, v84, v85
    v_cvt_pk_bf16_f32 v83, v86, v87
    s_cmp_lg_u32 s22, 0
    s_cbranch_scc1 L_w0_sequen_10
    v_lshlrev_b32 v6, 3, v1
    s_mov_b32 s51, 0
    s_mov_b32 exec_hi, 0
    s_mov_b32 exec_lo, 0xffffffff
L_poll_sequen_11:
    buffer_load_dwordx2 v[104:105], v6, s[24:27], s69 offen sc1
    s_add_u32 s51, s51, 1
    s_waitcnt vmcnt(0)
    v_cmp_eq_u64 vcc, v[104:105], v[4:5]
    s_cmp_gt_u32 s51, 400000
    s_cbranch_scc1 L_pdone_sequen_12
    s_cmp_eq_u64 vcc, exec
    s_cbranch_scc0 L_poll_sequen_11
L_pdone_sequen_12:
    s_mov_b64 exec, -1
L_w0_sequen_10:
    s_waitcnt vmcnt(0)
    s_barrier
    s_setprio 3
    v_exp_f32 v88, v88
    v_exp_f32 v89, v89
    v_mfma_f32_32x32x16_bf16 v[40:55], v[28:31], v[80:83], v[40:55]
    s_mov_b64 exec, s[54:55]
    ds_read_b128 v[24:27], v3 offset:6144
    ds_read_b128 v[28:31], v3 offset:6656
    s_mov_b64 exec, -1
    v_exp_f32 v90, v90
    v_exp_f32 v91, v91
    v_exp_f32 v92, v92
    s_add_u32 s72, s72, 8192
    s_and_b32 s72, s72, 0xffff
    s_add_u32 s50, s11, s72
    s_add_u32 m0, s12, 16384
    s_add_u32 s49, s50, 0x200000
    buffer_load_dwordx4 v1, s[24:27], s49 offen sc1 lds
    s_add_u32 m0, s12, 81920
    s_add_u32 s49, s50, 0x400000
    buffer_load_dwordx4 v1, s[24:27], s49 offen sc1 lds
    v_exp_f32 v93, v93
    v_exp_f32 v94, v94
    s_waitcnt lgkmcnt(3)
    v_mfma_f32_32x32x16_bf16 v[72:87], v[16:19], v[12:15], v[56:71]
    ds_read_b128 v[16:19], v1 offset:8192
    v_exp_f32 v95, v95
    v_cvt_pk_bf16_f32 v88, v88, v89
    v_cvt_pk_bf16_f32 v89, v90, v91
    v_cvt_pk_bf16_f32 v90, v92, v93
    v_cvt_pk_bf16_f32 v91, v94, v95
    v_exp_f32 v96, v96
    v_exp_f32 v97, v97
    v_mfma_f32_32x32x16_bf16 v[40:55], v[32:35], v[88:91], v[40:55]
    v_exp_f32 v98, v98
    v_exp_f32 v99, v99
    v_exp_f32 v100, v100
    v_exp_f32 v101, v101
    v_exp_f32 v102, v102
    v_exp_f32 v103, v103
    v_cvt_pk_bf16_f32 v96, v96, v97
    v_cvt_pk_bf16_f32 v97, v98, v99
    v_cvt_pk_bf16_f32 v98, v100, v101
    v_cvt_pk_bf16_f32 v99, v102, v103
    v_exp_f32 v72, v72
    v_exp_f32 v73, v73
    v_mfma_f32_32x32x16_bf16 v[40:55], v[36:39], v[96:99], v[40:55]
    s_mov_b64 exec, s[54:55]
    ds_read_b128 v[32:35], v3 offset:7168
    ds_read_b128 v[36:39], v3 offset:7680
    s_mov_b64 exec, -1
    v_exp_f32 v74, v74
    v_exp_f32 v75, v75
    v_exp_f32 v76, v76
    s_add_u32 s72, s72, 8192
    s_and_b32 s72, s72, 0xffff
    s_add_u32 s50, s11, s72
    s_add_u32 m0, s12, 24576
    s_add_u32 s49, s50, 0x200000
    buffer_load_dwordx4 v1, s[24:27], s49 offen sc1 lds
    s_add_u32 m0, s12, 90112
    s_add_u32 s49, s50, 0x400000
    buffer_load_dwordx4 v1, s[24:27], s49 offen sc1 lds
    v_exp_f32 v77, v77
    v_exp_f32 v78, v78
    s_waitcnt lgkmcnt(3)
    v_mfma_f32_32x32x16_bf16 v[88:103], v[20:23], v[12:15], v[56:71]
    ds_read_b128 v[20:23], v1 offset:9216
    v_exp_f32 v79, v79
    v_cvt_pk_bf16_f32 v72, v72, v73
    v_cvt_pk_bf16_f32 v73, v74, v75
    v_cvt_pk_bf16_f32 v74, v76, v77
    v_cvt_pk_bf16_f32 v75, v78, v79
    v_exp_f32 v80, v80
    v_exp_f32 v81, v81
    v_mfma_f32_32x32x16_bf16 v[40:55], v[24:27], v[72:75], v[40:55]
    v_exp_f32 v82, v82
    v_exp_f32 v83, v83
    v_exp_f32 v84, v84
    v_exp_f32 v85, v85
    v_exp_f32 v86, v86
    v_exp_f32 v87, v87
    v_cvt_pk_bf16_f32 v80, v80, v81
    v_cvt_pk_bf16_f32 v81, v82, v83
    v_cvt_pk_bf16_f32 v82, v84, v85
    v_cvt_pk_bf16_f32 v83, v86, v87
    v_exp_f32 v88, v88
    v_exp_f32 v89, v89
    v_mfma_f32_32x32x16_bf16 v[40:55], v[28:31], v[80:83], v[40:55]
    s_mov_b64 exec, s[54:55]
    ds_read_b128 v[24:27], v3 offset:8192
    ds_read_b128 v[28:31], v3 offset:8704
    s_mov_b64 exec, -1
    v_exp_f32 v90, v90
    v_exp_f32 v91, v91
    v_exp_f32 v92, v92
    s_add_u32 s72, s72, 8192
    s_and_b32 s72, s72, 0xffff
    s_add_u32 s50, s11, s72
    s_add_u32 m0, s12, 32768
    s_add_u32 s49, s50, 0x200000
    buffer_load_dwordx4 v1, s[24:27], s49 offen sc1 lds
    s_add_u32 m0, s12, 98304
    s_add_u32 s49, s50, 0x400000
    buffer_load_dwordx4 v1, s[24:27], s49 offen sc1 lds
    v_exp_f32 v93, v93
    v_exp_f32 v94, v94
    s_waitcnt lgkmcnt(3)
    v_mfma_f32_32x32x16_bf16 v[72:87], v[16:19], v[12:15], v[56:71]
    ds_read_b128 v[16:19], v1 offset:10240
    v_exp_f32 v95, v95
    v_cvt_pk_bf16_f32 v88, v88, v89
    v_cvt_pk_bf16_f32 v89, v90, v91
    v_cvt_pk_bf16_f32 v90, v92, v93
    v_cvt_pk_bf16_f32 v91, v94, v95
    v_exp_f32 v96, v96
    v_exp_f32 v97, v97
    v_mfma_f32_32x32x16_bf16 v[40:55], v[32:35], v[88:91], v[40:55]
    v_exp_f32 v98, v98
    v_exp_f32 v99, v99
    v_exp_f32 v100, v100
    v_exp_f32 v101, v101
    v_exp_f32 v102, v102
    v_exp_f32 v103, v103
    v_cvt_pk_bf16_f32 v96, v96, v97
    v_cvt_pk_bf16_f32 v97, v98, v99
    v_cvt_pk_bf16_f32 v98, v100, v101
    v_cvt_pk_bf16_f32 v99, v102, v103
    v_exp_f32 v72, v72
    v_exp_f32 v73, v73
    v_mfma_f32_32x32x16_bf16 v[40:55], v[36:39], v[96:99], v[40:55]
    s_mov_b64 exec, s[54:55]
    ds_read_b128 v[32:35], v3 offset:9216
    ds_read_b128 v[36:39], v3 offset:9728
    s_mov_b64 exec, -1
    v_exp_f32 v74, v74
    v_exp_f32 v75, v75
    v_exp_f32 v76, v76
    s_add_u32 s72, s72, 8192
    s_and_b32 s72, s72, 0xffff
    s_add_u32 s50, s11, s72
    s_add_u32 m0, s12, 40960
    s_add_u32 s49, s50, 0x200000
    buffer_load_dwordx4 v1, s[24:27], s49 offen sc1 lds
    s_add_u32 m0, s12, 106496
    s_add_u32 s49, s50, 0x400000
    buffer_load_dwordx4 v1, s[24:27], s49 offen sc1 lds
    v_exp_f32 v77, v77
    v_exp_f32 v78, v78
    s_waitcnt lgkmcnt(3)
    v_mfma_f32_32x32x16_bf16 v[88:103], v[20:23], v[12:15], v[56:71]
    ds_read_b128 v[20:23], v1 offset:11264
    v_exp_f32 v79, v79
    v_cvt_pk_bf16_f32 v72, v72, v73
    v_cvt_pk_bf16_f32 v73, v74, v75
    v_cvt_pk_bf16_f32 v74, v76, v77
    v_cvt_pk_bf16_f32 v75, v78, v79
    v_exp_f32 v80, v80
    v_exp_f32 v81, v81
    v_mfma_f32_32x32x16_bf16 v[40:55], v[24:27], v[72:75], v[40:55]
    v_exp_f32 v82, v82
    v_exp_f32 v83, v83
    v_exp_f32 v84, v84
    v_exp_f32 v85, v85
    v_exp_f32 v86, v86
    v_exp_f32 v87, v87
    v_cvt_pk_bf16_f32 v80, v80, v81
    v_cvt_pk_bf16_f32 v81, v82, v83
    v_cvt_pk_bf16_f32 v82, v84, v85
    v_cvt_pk_bf16_f32 v83, v86, v87
    s_setprio 2
    v_exp_f32 v88, v88
    v_exp_f32 v89, v89
    v_mfma_f32_32x32x16_bf16 v[40:55], v[28:31], v[80:83], v[40:55]
    s_mov_b64 exec, s[54:55]
    ds_read_b128 v[24:27], v3 offset:10240
    ds_read_b128 v[28:31], v3 offset:10752
    s_mov_b64 exec, -1
    v_exp_f32 v90, v90
    v_exp_f32 v91, v91
    v_exp_f32 v92, v92
    s_add_u32 s72, s72, 8192
    s_and_b32 s72, s72, 0xffff
    s_add_u32 s50, s11, s72
    s_add_u32 m0, s12, 49152
    s_add_u32 s49, s50, 0x200000
    buffer_load_dwordx4 v1, s[24:27], s49 offen sc1 lds
    s_add_u32 m0, s12, 114688
    s_add_u32 s49, s50, 0x400000
    buffer_load_dwordx4 v1, s[24:27], s49 offen sc1 lds
    v_exp_f32 v93, v93
    v_exp_f32 v94, v94
    s_waitcnt lgkmcnt(3)
    v_mfma_f32_32x32x16_bf16 v[72:87], v[16:19], v[12:15], v[56:71]
    ds_read_b128 v[16:19], v1 offset:12288
    v_exp_f32 v95, v95
    v_cvt_pk_bf16_f32 v88, v88, v89
    v_cvt_pk_bf16_f32 v89, v90, v91
    v_cvt_pk_bf16_f32 v90, v92, v93
    v_cvt_pk_bf16_f32 v91, v94, v95
    v_exp_f32 v96, v96
    v_exp_f32 v97, v97
    v_mfma_f32_32x32x16_bf16 v[40:55], v[32:35], v[88:91], v[40:55]
    v_exp_f32 v98, v98
    v_exp_f32 v99, v99
    v_exp_f32 v100, v100
    v_exp_f32 v101, v101
    v_exp_f32 v102, v102
    v_exp_f32 v103, v103
    v_cvt_pk_bf16_f32 v96, v96, v97
    v_cvt_pk_bf16_f32 v97, v98, v99
    v_cvt_pk_bf16_f32 v98, v100, v101
    v_cvt_pk_bf16_f32 v99, v102, v103
    v_exp_f32 v72, v72
    v_exp_f32 v73, v73
    v_mfma_f32_32x32x16_bf16 v[40:55], v[36:39], v[96:99], v[40:55]
    s_mov_b64 exec, s[54:55]
    ds_read_b128 v[32:35], v3 offset:11264
    ds_read_b128 v[36:39], v3 offset:11776
    s_mov_b64 exec, -1
    v_exp_f32 v74, v74
    v_exp_f32 v75, v75
    v_exp_f32 v76, v76
    s_add_u32 s72, s72, 8192
    s_and_b32 s72, s72, 0xffff
    s_add_u32 s50, s11, s72
    s_add_u32 m0, s12, 57344
    s_add_u32 s49, s50, 0x200000
    buffer_load_dwordx4 v1, s[24:27], s49 offen sc1 lds
    s_add_u32 m0, s12, 122880
    s_add_u32 s49, s50, 0x400000
    buffer_load_dwordx4 v1, s[24:27], s49 offen sc1 lds
    v_exp_f32 v77, v77
    v_exp_f32 v78, v78
    s_waitcnt lgkmcnt(3)
    v_mfma_f32_32x32x16_bf16 v[88:103], v[20:23], v[12:15], v[56:71]
    ds_read_b128 v[20:23], v1 offset:13312
    v_exp_f32 v79, v79
    v_cvt_pk_bf16_f32 v72, v72, v73
    v_cvt_pk_bf16_f32 v73, v74, v75
    v_cvt_pk_bf16_f32 v74, v76, v77
    v_cvt_pk_bf16_f32 v75, v78, v79
    v_exp_f32 v80, v80
    v_exp_f32 v81, v81
    v_mfma_f32_32x32x16_bf16 v[40:55], v[24:27], v[72:75], v[40:55]
    v_exp_f32 v82, v82
    v_exp_f32 v83, v83
    v_exp_f32 v84, v84
    v_exp_f32 v85, v85
    v_exp_f32 v86, v86
    v_exp_f32 v87, v87
    v_cvt_pk_bf16_f32 v80, v80, v81
    v_cvt_pk_bf16_f32 v81, v82, v83
    v_cvt_pk_bf16_f32 v82, v84, v85
    v_cvt_pk_bf16_f32 v83, v86, v87
    s_setprio 1
    v_exp_f32 v88, v88
    v_exp_f32 v89, v89
    v_mfma_f32_32x32x16_bf16 v[40:55], v[28:31], v[80:83], v[40:55]
    s_mov_b64 exec, s[54:55]
    ds_read_b128 v[24:27], v3 offset:12288
    ds_read_b128 v[28:31], v3 offset:12800
    s_mov_b64 exec, -1
    v_exp_f32 v90, v90
    v_exp_f32 v91, v91
    v_exp_f32 v92, v92
    v_exp_f32 v93, v93
    v_exp_f32 v94, v94
    s_waitcnt lgkmcnt(3)
    v_mfma_f32_32x32x16_bf16 v[72:87], v[16:19], v[12:15], v[56:71]
    ds_read_b128 v[16:19], v1 offset:14336
    v_exp_f32 v95, v95
    v_cvt_pk_bf16_f32 v88, v88, v89
    v_cvt_pk_bf16_f32 v89, v90, v91
    v_cvt_pk_bf16_f32 v90, v92, v93
    v_cvt_pk_bf16_f32 v91, v94, v95
    v_exp_f32 v96, v96
    v_exp_f32 v97, v97
    v_mfma_f32_32x32x16_bf16 v[40:55], v[32:35], v[88:91], v[40:55]
    v_exp_f32 v98, v98
    v_exp_f32 v99, v99
    v_exp_f32 v100, v100
    v_exp_f32 v101, v101
    v_exp_f32 v102, v102
    v_exp_f32 v103, v103
    v_cvt_pk_bf16_f32 v96, v96, v97
    v_cvt_pk_bf16_f32 v97, v98, v99
    v_cvt_pk_bf16_f32 v98, v100, v101
    v_cvt_pk_bf16_f32 v99, v102, v103
    s_setprio 0
    v_exp_f32 v72, v72
    v_exp_f32 v73, v73
    v_mfma_f32_32x32x16_bf16 v[40:55], v[36:39], v[96:99], v[40:55]
    s_mov_b64 exec, s[54:55]
    ds_read_b128 v[32:35], v3 offset:13312
    ds_read_b128 v[36:39], v3 offset:13824
    s_mov_b64 exec, -1
    v_exp_f32 v74, v74
    v_exp_f32 v75, v75
    v_exp_f32 v76, v76
    v_exp_f32 v77, v77
    v_exp_f32 v78, v78
    s_waitcnt lgkmcnt(3)
    v_mfma_f32_32x32x16_bf16 v[88:103], v[20:23], v[12:15], v[56:71]
    ds_read_b128 v[20:23], v1 offset:15360
    v_exp_f32 v79, v79
    v_cvt_pk_bf16_f32 v72, v72, v73
    v_cvt_pk_bf16_f32 v73, v74, v75
    v_cvt_pk_bf16_f32 v74, v76, v77
    v_cvt_pk_bf16_f32 v75, v78, v79
    v_exp_f32 v80, v80
    v_exp_f32 v81, v81
    v_mfma_f32_32x32x16_bf16 v[40:55], v[24:27], v[72:75], v[40:55]
    v_exp_f32 v82, v82
    v_exp_f32 v83, v83
    v_exp_f32 v84, v84
    v_exp_f32 v85, v85
    v_exp_f32 v86, v86
    v_exp_f32 v87, v87
    v_cvt_pk_bf16_f32 v80, v80, v81
    v_cvt_pk_bf16_f32 v81, v82, v83
    v_cvt_pk_bf16_f32 v82, v84, v85
    v_cvt_pk_bf16_f32 v83, v86, v87
    s_waitcnt vmcnt(0)
    s_barrier
    s_cmp_lt_u32 s22, 4
    s_cbranch_scc1 L_ho_sequen_13
    s_add_u32 m0, s71, 0
    s_nop 0
    buffer_load_dwordx4 v112, s[40:43], s59 offen lds
    s_add_u32 m0, s71, 1024
    s_add_u32 s59, s59, s64
    buffer_load_dwordx4 v112, s[40:43], s59 offen lds
    s_add_u32 m0, s71, 2048
    s_add_u32 s59, s59, s64
    buffer_load_dwordx4 v112, s[40:43], s59 offen lds
    s_add_u32 m0, s71, 3072
    s_add_u32 s59, s59, s64
    buffer_load_dwordx4 v112, s[40:43], s59 offen lds
L_ho_sequen_13:
    s_setprio 3
    v_exp_f32 v88, v88
    v_exp_f32 v89, v89
    v_mfma_f32_32x32x16_bf16 v[40:55], v[28:31], v[80:83], v[40:55]
    s_mov_b64 exec, s[54:55]
    ds_read_b128 v[24:27], v3 offset:14336
    ds_read_b128 v[28:31], v3 offset:14848
    s_mov_b64 exec, -1
    v_exp_f32 v90, v90
    v_exp_f32 v91, v91
    v_exp_f32 v92, v92
    v_exp_f32 v93, v93
    v_exp_f32 v94, v94
    s_waitcnt lgkmcnt(3)
    v_mfma_f32_32x32x16_bf16 v[72:87], v[16:19], v[12:15], v[56:71]
    ds_read_b128 v[16:19], v1 offset:16384
    v_exp_f32 v95, v95
    v_cvt_pk_bf16_f32 v88, v88, v89
    v_cvt_pk_bf16_f32 v89, v90, v91
    v_cvt_pk_bf16_f32 v90, v92, v93
    v_cvt_pk_bf16_f32 v91, v94, v95
    v_exp_f32 v96, v96
    v_exp_f32 v97, v97
    v_mfma_f32_32x32x16_bf16 v[40:55], v[32:35], v[88:91], v[40:55]
    v_exp_f32 v98, v98
    v_exp_f32 v99, v99
    v_exp_f32 v100, v100
    v_exp_f32 v101, v101
    v_exp_f32 v102, v102
    v_exp_f32 v103, v103
    v_cvt_pk_bf16_f32 v96, v96, v97
    v_cvt_pk_bf16_f32 v97, v98, v99
    v_cvt_pk_bf16_f32 v98, v100, v101
    v_cvt_pk_bf16_f32 v99, v102, v103
    v_exp_f32 v72, v72
    v_exp_f32 v73, v73
    v_mfma_f32_32x32x16_bf16 v[40:55], v[36:39], v[96:99], v[40:55]
    s_mov_b64 exec, s[54:55]
    ds_read_b128 v[32:35], v3 offset:15360
    ds_read_b128 v[36:39], v3 offset:15872
    s_mov_b64 exec, -1
    v_exp_f32 v74, v74
    v_exp_f32 v75, v75
    v_exp_f32 v76, v76
    v_exp_f32 v77, v77
    v_exp_f32 v78, v78
    s_waitcnt lgkmcnt(3)
    v_mfma_f32_32x32x16_bf16 v[88:103], v[20:23], v[12:15], v[56:71]
    ds_read_b128 v[20:23], v1 offset:17408
    v_exp_f32 v79, v79
    v_cvt_pk_bf16_f32 v72, v72, v73
    v_cvt_pk_bf16_f32 v73, v74, v75
    v_cvt_pk_bf16_f32 v74, v76, v77
    v_cvt_pk_bf16_f32 v75, v78, v79
    v_exp_f32 v80, v80
    v_exp_f32 v81, v81
    v_mfma_f32_32x32x16_bf16 v[40:55], v[24:27], v[72:75], v[40:55]
    v_exp_f32 v82, v82
    v_exp_f32 v83, v83
    v_exp_f32 v84, v84
    v_exp_f32 v85, v85
    v_exp_f32 v86, v86
    v_exp_f32 v87, v87
    v_cvt_pk_bf16_f32 v80, v80, v81
    v_cvt_pk_bf16_f32 v81, v82, v83
    v_cvt_pk_bf16_f32 v82, v84, v85
    v_cvt_pk_bf16_f32 v83, v86, v87
    v_exp_f32 v88, v88
    v_exp_f32 v89, v89
    v_mfma_f32_32x32x16_bf16 v[40:55], v[28:31], v[80:83], v[40:55]
    s_mov_b64 exec, s[54:55]
    ds_read_b128 v[24:27], v3 offset:16384
    ds_read_b128 v[28:31], v3 offset:16896
    s_mov_b64 exec, -1
    v_exp_f32 v90, v90
    v_exp_f32 v91, v91
    v_exp_f32 v92, v92
    v_exp_f32 v93, v93
    v_exp_f32 v94, v94
    s_waitcnt lgkmcnt(3)
    v_mfma_f32_32x32x16_bf16 v[72:87], v[16:19], v[12:15], v[56:71]
    ds_read_b128 v[16:19], v1 offset:18432
    v_exp_f32 v95, v95
    v_cvt_pk_bf16_f32 v88, v88, v89
    v_cvt_pk_bf16_f32 v89, v90, v91
    v_cvt_pk_bf16_f32 v90, v92, v93
    v_cvt_pk_bf16_f32 v91, v94, v95
    v_exp_f32 v96, v96
    v_exp_f32 v97, v97
    v_mfma_f32_32x32x16_bf16 v[40:55], v[32:35], v[88:91], v[40:55]
    v_exp_f32 v98, v98
    v_exp_f32 v99, v99
    v_exp_f32 v100, v100
    v_exp_f32 v101, v101
    v_exp_f32 v102, v102
    v_exp_f32 v103, v103
    v_cvt_pk_bf16_f32 v96, v96, v97
    v_cvt_pk_bf16_f32 v97, v98, v99
    v_cvt_pk_bf16_f32 v98, v100, v101
    v_cvt_pk_bf16_f32 v99, v102, v103
    v_exp_f32 v72, v72
    v_exp_f32 v73, v73
    v_mfma_f32_32x32x16_bf16 v[40:55], v[36:39], v[96:99], v[40:55]
    s_mov_b64 exec, s[54:55]
    ds_read_b128 v[32:35], v3 offset:17408
    ds_read_b128 v[36:39], v3 offset:17920
    s_mov_b64 exec, -1
    v_exp_f32 v74, v74
    v_exp_f32 v75, v75
    v_exp_f32 v76, v76
    v_exp_f32 v77, v77
    v_exp_f32 v78, v78
    s_waitcnt lgkmcnt(3)
    v_mfma_f32_32x32x16_bf16 v[88:103], v[20:23], v[12:15], v[56:71]
    ds_read_b128 v[20:23], v1 offset:19456
    v_exp_f32 v79, v79
    v_cvt_pk_bf16_f32 v72, v72, v73
    v_cvt_pk_bf16_f32 v73, v74, v75
    v_cvt_pk_bf16_f32 v74, v76, v77
    v_cvt_pk_bf16_f32 v75, v78, v79
    v_exp_f32 v80, v80
    v_exp_f32 v81, v81
    v_mfma_f32_32x32x16_bf16 v[40:55], v[24:27], v[72:75], v[40:55]
    v_exp_f32 v82, v82
    v_exp_f32 v83, v83
    v_exp_f32 v84, v84
    v_exp_f32 v85, v85
    v_exp_f32 v86, v86
    v_exp_f32 v87, v87
    v_cvt_pk_bf16_f32 v80, v80, v81
    v_cvt_pk_bf16_f32 v81, v82, v83
    v_cvt_pk_bf16_f32 v82, v84, v85
    v_cvt_pk_bf16_f32 v83, v86, v87
    v_exp_f32 v88, v88
    v_exp_f32 v89, v89
    v_mfma_f32_32x32x16_bf16 v[40:55], v[28:31], v[80:83], v[40:55]
    s_mov_b64 exec, s[54:55]
    ds_read_b128 v[24:27], v3 offset:18432
    ds_read_b128 v[28:31], v3 offset:18944
    s_mov_b64 exec, -1
    v_exp_f32 v90, v90
    v_exp_f32 v91, v91
    v_exp_f32 v92, v92
    v_exp_f32 v93, v93
    v_exp_f32 v94, v94
    s_waitcnt lgkmcnt(3)
    v_mfma_f32_32x32x16_bf16 v[72:87], v[16:19], v[12:15], v[56:71]
    ds_read_b128 v[16:19], v1 offset:20480
    v_exp_f32 v95, v95
    v_cvt_pk_bf16_f32 v88, v88, v89
    v_cvt_pk_bf16_f32 v89, v90, v91
    v_cvt_pk_bf16_f32 v90, v92, v93
    v_cvt_pk_bf16_f32 v91, v94, v95
    v_exp_f32 v96, v96
    v_exp_f32 v97, v97
    v_mfma_f32_32x32x16_bf16 v[40:55], v[32:35], v[88:91], v[40:55]
    v_exp_f32 v98, v98
    v_exp_f32 v99, v99
    v_exp_f32 v100, v100
    v_exp_f32 v101, v101
    v_exp_f32 v102, v102
    v_exp_f32 v103, v103
    v_cvt_pk_bf16_f32 v96, v96, v97
    v_cvt_pk_bf16_f32 v97, v98, v99
    v_cvt_pk_bf16_f32 v98, v100, v101
    v_cvt_pk_bf16_f32 v99, v102, v103
    v_exp_f32 v72, v72
    v_exp_f32 v73, v73
    v_mfma_f32_32x32x16_bf16 v[40:55], v[36:39], v[96:99], v[40:55]
    s_mov_b64 exec, s[54:55]
    ds_read_b128 v[32:35], v3 offset:19456
    ds_read_b128 v[36:39], v3 offset:19968
    s_mov_b64 exec, -1
    v_exp_f32 v74, v74
    v_exp_f32 v75, v75
    v_exp_f32 v76, v76
    v_exp_f32 v77, v77
    v_exp_f32 v78, v78
    s_waitcnt lgkmcnt(3)
    v_mfma_f32_32x32x16_bf16 v[88:103], v[20:23], v[12:15], v[56:71]
    ds_read_b128 v[20:23], v1 offset:21504
    v_exp_f32 v79, v79
    v_cvt_pk_bf16_f32 v72, v72, v73
    v_cvt_pk_bf16_f32 v73, v74, v75
    v_cvt_pk_bf16_f32 v74, v76, v77
    v_cvt_pk_bf16_f32 v75, v78, v79
    v_exp_f32 v80, v80
    v_exp_f32 v81, v81
    v_mfma_f32_32x32x16_bf16 v[40:55], v[24:27], v[72:75], v[40:55]
    v_exp_f32 v82, v82
    v_exp_f32 v83, v83
    v_exp_f32 v84, v84
    v_exp_f32 v85, v85
    v_exp_f32 v86, v86
    v_exp_f32 v87, v87
    v_cvt_pk_bf16_f32 v80, v80, v81
    v_cvt_pk_bf16_f32 v81, v82, v83
    v_cvt_pk_bf16_f32 v82, v84, v85
    v_cvt_pk_bf16_f32 v83, v86, v87
    v_exp_f32 v88, v88
    v_exp_f32 v89, v89
    v_mfma_f32_32x32x16_bf16 v[40:55], v[28:31], v[80:83], v[40:55]
    s_mov_b64 exec, s[54:55]
    ds_read_b128 v[24:27], v3 offset:20480
    ds_read_b128 v[28:31], v3 offset:20992
    s_mov_b64 exec, -1
    v_exp_f32 v90, v90
    v_exp_f32 v91, v91
    v_exp_f32 v92, v92
    v_exp_f32 v93, v93
    v_exp_f32 v94, v94
    s_waitcnt lgkmcnt(3)
    v_mfma_f32_32x32x16_bf16 v[72:87], v[16:19], v[12:15], v[56:71]
    ds_read_b128 v[16:19], v1 offset:22528
    v_exp_f32 v95, v95
    v_cvt_pk_bf16_f32 v88, v88, v89
    v_cvt_pk_bf16_f32 v89, v90, v91
    v_cvt_pk_bf16_f32 v90, v92, v93
    v_cvt_pk_bf16_f32 v91, v94, v95
    v_exp_f32 v96, v96
    v_exp_f32 v97, v97
    v_mfma_f32_32x32x16_bf16 v[40:55], v[32:35], v[88:91], v[40:55]
    v_exp_f32 v98, v98
    v_exp_f32 v99, v99
    v_exp_f32 v100, v100
    v_exp_f32 v101, v101
    v_exp_f32 v102, v102
    v_exp_f32 v103, v103
    v_cvt_pk_bf16_f32 v96, v96, v97
    v_cvt_pk_bf16_f32 v97, v98, v99
    v_cvt_pk_bf16_f32 v98, v100, v101
    v_cvt_pk_bf16_f32 v99, v102, v103
    v_exp_f32 v72, v72
    v_exp_f32 v73, v73
    v_mfma_f32_32x32x16_bf16 v[40:55], v[36:39], v[96:99], v[40:55]
    s_mov_b64 exec, s[54:55]
    ds_read_b128 v[32:35], v3 offset:21504
    ds_read_b128 v[36:39], v3 offset:22016
    s_mov_b64 exec, -1
    v_exp_f32 v74, v74
    v_exp_f32 v75, v75
    v_exp_f32 v76, v76
    v_exp_f32 v77, v77
    v_exp_f32 v78, v78
    s_waitcnt lgkmcnt(3)
    v_mfma_f32_32x32x16_bf16 v[88:103], v[20:23], v[12:15], v[56:71]
    ds_read_b128 v[20:23], v1 offset:23552
    v_exp_f32 v79, v79
    v_cvt_pk_bf16_f32 v72, v72, v73
    v_cvt_pk_bf16_f32 v73, v74, v75
    v_cvt_pk_bf16_f32 v74, v76, v77
    v_cvt_pk_bf16_f32 v75, v78, v79
    v_exp_f32 v80, v80
    v_exp_f32 v81, v81
    v_mfma_f32_32x32x16_bf16 v[40:55], v[24:27], v[72:75], v[40:55]
    v_exp_f32 v82, v82
    v_exp_f32 v83, v83
    v_exp_f32 v84, v84
    v_exp_f32 v85, v85
    v_exp_f32 v86, v86
    v_exp_f32 v87, v87
    v_cvt_pk_bf16_f32 v80, v80, v81
    v_cvt_pk_bf16_f32 v81, v82, v83
    v_cvt_pk_bf16_f32 v82, v84, v85
    v_cvt_pk_bf16_f32 v83, v86, v87
    v_exp_f32 v88, v88
    v_exp_f32 v89, v89
    v_mfma_f32_32x32x16_bf16 v[40:55], v[28:31], v[80:83], v[40:55]
    s_mov_b64 exec, s[54:55]
    ds_read_b128 v[24:27], v3 offset:22528
    ds_read_b128 v[28:31], v3 offset:23040
    s_mov_b64 exec, -1
    v_exp_f32 v90, v90
    v_exp_f32 v91, v91
    v_exp_f32 v92, v92
    v_exp_f32 v93, v93
    v_exp_f32 v94, v94
    s_waitcnt lgkmcnt(3)
    v_mfma_f32_32x32x16_bf16 v[72:87], v[16:19], v[12:15], v[56:71]
    ds_read_b128 v[16:19], v1 offset:24576
    v_exp_f32 v95, v95
    v_cvt_pk_bf16_f32 v88, v88, v89
    v_cvt_pk_bf16_f32 v89, v90, v91
    v_cvt_pk_bf16_f32 v90, v92, v93
    v_cvt_pk_bf16_f32 v91, v94, v95
    v_exp_f32 v96, v96
    v_exp_f32 v97, v97
    v_mfma_f32_32x32x16_bf16 v[40:55], v[32:35], v[88:91], v[40:55]
    v_exp_f32 v98, v98
    v_exp_f32 v99, v99
    v_exp_f32 v100, v100
    v_exp_f32 v101, v101
    v_exp_f32 v102, v102
    v_exp_f32 v103, v103
    v_cvt_pk_bf16_f32 v96, v96, v97
    v_cvt_pk_bf16_f32 v97, v98, v99
    v_cvt_pk_bf16_f32 v98, v100, v101
    v_cvt_pk_bf16_f32 v99, v102, v103
    s_cmp_lt_u32 s22, 4
    s_cbranch_scc1 L_ho_sequen_15
    s_waitcnt vmcnt(0)
    ds_read_b64_tr_b16 v[128:129], v113 offset:0
    ds_read_b64_tr_b16 v[130:131], v113 offset:512
    ds_read_b64_tr_b16 v[132:133], v113 offset:1024
    ds_read_b64_tr_b16 v[134:135], v113 offset:1536
    ds_read_b64_tr_b16 v[136:137], v113 offset:2048
    ds_read_b64_tr_b16 v[138:139], v113 offset:2560
    ds_read_b64_tr_b16 v[140:141], v113 offset:3072
    ds_read_b64_tr_b16 v[142:143], v113 offset:3584
    s_waitcnt lgkmcnt(0)
    buffer_store_dwordx4 v[128:131], v1, s[24:27], s58 offen sc1
    buffer_store_dwordx4 v[132:135], v1, s[24:27], s58 offen offset:1024 sc1
    buffer_store_dwordx4 v[136:139], v1, s[24:27], s58 offen offset:2048 sc1
    buffer_store_dwordx4 v[140:143], v1, s[24:27], s58 offen offset:3072 sc1
L_ho_sequen_15:
    v_exp_f32 v72, v72
    v_exp_f32 v73, v73
    v_mfma_f32_32x32x16_bf16 v[40:55], v[36:39], v[96:99], v[40:55]
    s_mov_b64 exec, s[54:55]
    ds_read_b128 v[32:35], v3 offset:23552
    ds_read_b128 v[36:39], v3 offset:24064
    s_mov_b64 exec, -1
    v_exp_f32 v74, v74
    v_exp_f32 v75, v75
    v_exp_f32 v76, v76
    v_exp_f32 v77, v77
    v_exp_f32 v78, v78
    s_waitcnt lgkmcnt(3)
    v_mfma_f32_32x32x16_bf16 v[88:103], v[20:23], v[12:15], v[56:71]
    ds_read_b128 v[20:23], v1 offset:25600
    v_exp_f32 v79, v79
    v_cvt_pk_bf16_f32 v72, v72, v73
    v_cvt_pk_bf16_f32 v73, v74, v75
    v_cvt_pk_bf16_f32 v74, v76, v77
    v_cvt_pk_bf16_f32 v75, v78, v79
    v_exp_f32 v80, v80
    v_exp_f32 v81, v81
    v_mfma_f32_32x32x16_bf16 v[40:55], v[24:27], v[72:75], v[40:55]
    v_exp_f32 v82, v82
    v_exp_f32 v83, v83
    v_exp_f32 v84, v84
    v_exp_f32 v85, v85
    v_exp_f32 v86, v86
    v_exp_f32 v87, v87
    v_cvt_pk_bf16_f32 v80, v80, v81
    v_cvt_pk_bf16_f32 v81, v82, v83
    v_cvt_pk_bf16_f32 v82, v84, v85
    v_cvt_pk_bf16_f32 v83, v86, v87
    v_exp_f32 v88, v88
    v_exp_f32 v89, v89
    v_mfma_f32_32x32x16_bf16 v[40:55], v[28:31], v[80:83], v[40:55]
    s_mov_b64 exec, s[54:55]
    ds_read_b128 v[24:27], v3 offset:24576
    ds_read_b128 v[28:31], v3 offset:25088
    s_mov_b64 exec, -1
    v_exp_f32 v90, v90
    v_exp_f32 v91, v91
    v_exp_f32 v92, v92
    v_exp_f32 v93, v93
    v_exp_f32 v94, v94
    s_waitcnt lgkmcnt(3)
    v_mfma_f32_32x32x16_bf16 v[72:87], v[16:19], v[12:15], v[56:71]
    ds_read_b128 v[16:19], v1 offset:26624
    v_exp_f32 v95, v95
    v_cvt_pk_bf16_f32 v88, v88, v89
    v_cvt_pk_bf16_f32 v89, v90, v91
    v_cvt_pk_bf16_f32 v90, v92, v93
    v_cvt_pk_bf16_f32 v91, v94, v95
    v_exp_f32 v96, v96
    v_exp_f32 v97, v97
    v_mfma_f32_32x32x16_bf16 v[40:55], v[32:35], v[88:91], v[40:55]
    v_exp_f32 v98, v98
    v_exp_f32 v99, v99
    v_exp_f32 v100, v100
    v_exp_f32 v101, v101
    v_exp_f32 v102, v102
    v_exp_f32 v103, v103
    v_cvt_pk_bf16_f32 v96, v96, v97
    v_cvt_pk_bf16_f32 v97, v98, v99
    v_cvt_pk_bf16_f32 v98, v100, v101
    v_cvt_pk_bf16_f32 v99, v102, v103
    v_exp_f32 v72, v72
    v_exp_f32 v73, v73
    v_mfma_f32_32x32x16_bf16 v[40:55], v[36:39], v[96:99], v[40:55]
    s_mov_b64 exec, s[54:55]
    ds_read_b128 v[32:35], v3 offset:25600
    ds_read_b128 v[36:39], v3 offset:26112
    s_mov_b64 exec, -1
    v_exp_f32 v74, v74
    v_exp_f32 v75, v75
    v_exp_f32 v76, v76
    v_exp_f32 v77, v77
    v_exp_f32 v78, v78
    s_waitcnt lgkmcnt(3)
    v_mfma_f32_32x32x16_bf16 v[88:103], v[20:23], v[12:15], v[56:71]
    ds_read_b128 v[20:23], v1 offset:27648
    v_exp_f32 v79, v79
    v_cvt_pk_bf16_f32 v72, v72, v73
    v_cvt_pk_bf16_f32 v73, v74, v75
    v_cvt_pk_bf16_f32 v74, v76, v77
    v_cvt_pk_bf16_f32 v75, v78, v79
    v_exp_f32 v80, v80
    v_exp_f32 v81, v81
    v_mfma_f32_32x32x16_bf16 v[40:55], v[24:27], v[72:75], v[40:55]
    v_exp_f32 v82, v82
    v_exp_f32 v83, v83
    v_exp_f32 v84, v84
    v_exp_f32 v85, v85
    v_exp_f32 v86, v86
    v_exp_f32 v87, v87
    v_cvt_pk_bf16_f32 v80, v80, v81
    v_cvt_pk_bf16_f32 v81, v82, v83
    v_cvt_pk_bf16_f32 v82, v84, v85
    v_cvt_pk_bf16_f32 v83, v86, v87
    v_exp_f32 v88, v88
    v_exp_f32 v89, v89
    v_mfma_f32_32x32x16_bf16 v[40:55], v[28:31], v[80:83], v[40:55]
    s_mov_b64 exec, s[54:55]
    ds_read_b128 v[24:27], v3 offset:26624
    ds_read_b128 v[28:31], v3 offset:27136
    s_mov_b64 exec, -1
    v_exp_f32 v90, v90
    v_exp_f32 v91, v91
    v_exp_f32 v92, v92
    v_exp_f32 v93, v93
    v_exp_f32 v94, v94
    s_waitcnt lgkmcnt(3)
    v_mfma_f32_32x32x16_bf16 v[72:87], v[16:19], v[12:15], v[56:71]
    ds_read_b128 v[16:19], v1 offset:28672
    v_exp_f32 v95, v95
    v_cvt_pk_bf16_f32 v88, v88, v89
    v_cvt_pk_bf16_f32 v89, v90, v91
    v_cvt_pk_bf16_f32 v90, v92, v93
    v_cvt_pk_bf16_f32 v91, v94, v95
    v_exp_f32 v96, v96
    v_exp_f32 v97, v97
    v_mfma_f32_32x32x16_bf16 v[40:55], v[32:35], v[88:91], v[40:55]
    v_exp_f32 v98, v98
    v_exp_f32 v99, v99
    v_exp_f32 v100, v100
    v_exp_f32 v101, v101
    v_exp_f32 v102, v102
    v_exp_f32 v103, v103
    v_cvt_pk_bf16_f32 v96, v96, v97
    v_cvt_pk_bf16_f32 v97, v98, v99
    v_cvt_pk_bf16_f32 v98, v100, v101
    v_cvt_pk_bf16_f32 v99, v102, v103
    s_cmp_lt_u32 s22, 4
    s_cbranch_scc1 L_ho_sequen_17
    s_waitcnt vmcnt(0)
    v_lshrrev_b32 v6, 1, v1
    s_lshl_b32 s48, s2, 2
    s_add_u32 s48, s48, s23
    s_lshl_b32 s48, s48, 7
    s_add_u32 s48, s48, 0x1788000
    s_mov_b64 exec, 0xffff
    buffer_store_dwordx2 v[4:5], v6, s[24:27], s48 offen sc1
    s_mov_b64 exec, -1
L_ho_sequen_17:
    v_exp_f32 v72, v72
    v_exp_f32 v73, v73
    v_mfma_f32_32x32x16_bf16 v[40:55], v[36:39], v[96:99], v[40:55]
    s_mov_b64 exec, s[54:55]
    ds_read_b128 v[32:35], v3 offset:27648
    ds_read_b128 v[36:39], v3 offset:28160
    s_mov_b64 exec, -1
    v_exp_f32 v74, v74
    v_exp_f32 v75, v75
    v_exp_f32 v76, v76
    v_exp_f32 v77, v77
    v_exp_f32 v78, v78
    s_waitcnt lgkmcnt(3)
    v_mfma_f32_32x32x16_bf16 v[88:103], v[20:23], v[12:15], v[56:71]
    ds_read_b128 v[20:23], v1 offset:29696
    v_exp_f32 v79, v79
    v_cvt_pk_bf16_f32 v72, v72, v73
    v_cvt_pk_bf16_f32 v73, v74, v75
    v_cvt_pk_bf16_f32 v74, v76, v77
    v_cvt_pk_bf16_f32 v75, v78, v79
    v_exp_f32 v80, v80
    v_exp_f32 v81, v81
    v_mfma_f32_32x32x16_bf16 v[40:55], v[24:27], v[72:75], v[40:55]
    v_exp_f32 v82, v82
    v_exp_f32 v83, v83
    v_exp_f32 v84, v84
    v_exp_f32 v85, v85
    v_exp_f32 v86, v86
    v_exp_f32 v87, v87
    v_cvt_pk_bf16_f32 v80, v80, v81
    v_cvt_pk_bf16_f32 v81, v82, v83
    v_cvt_pk_bf16_f32 v82, v84, v85
    v_cvt_pk_bf16_f32 v83, v86, v87
    v_exp_f32 v88, v88
    v_exp_f32 v89, v89
    v_mfma_f32_32x32x16_bf16 v[40:55], v[28:31], v[80:83], v[40:55]
    s_mov_b64 exec, s[54:55]
    ds_read_b128 v[24:27], v3 offset:28672
    ds_read_b128 v[28:31], v3 offset:29184
    s_mov_b64 exec, -1
    v_exp_f32 v90, v90
    v_exp_f32 v91, v91
    v_exp_f32 v92, v92
    s_and_b32 exec_lo, s63, 0x7ff
    s_mov_b32 exec_hi, 0x0
    s_or_b32 exec_hi, exec_hi, 1
    buffer_load_dword v115, v114, s[24:27], 0 offen
    s_mov_b64 exec, -1
    v_exp_f32 v93, v93
    v_exp_f32 v94, v94
    s_waitcnt lgkmcnt(3)
    v_mfma_f32_32x32x16_bf16 v[72:87], v[16:19], v[12:15], v[56:71]
    ds_read_b128 v[16:19], v1 offset:30720
    v_exp_f32 v95, v95
    v_cvt_pk_bf16_f32 v88, v88, v89
    v_cvt_pk_bf16_f32 v89, v90, v91
    v_cvt_pk_bf16_f32 v90, v92, v93
    v_cvt_pk_bf16_f32 v91, v94, v95
    v_exp_f32 v96, v96
    v_exp_f32 v97, v97
    v_mfma_f32_32x32x16_bf16 v[40:55], v[32:35], v[88:91], v[40:55]
    v_exp_f32 v98, v98
    v_exp_f32 v99, v99
    v_exp_f32 v100, v100
    v_exp_f32 v101, v101
    v_exp_f32 v102, v102
    v_exp_f32 v103, v103
    v_cvt_pk_bf16_f32 v96, v96, v97
    v_cvt_pk_bf16_f32 v97, v98, v99
    v_cvt_pk_bf16_f32 v98, v100, v101
    v_cvt_pk_bf16_f32 v99, v102, v103
    v_exp_f32 v72, v72
    v_exp_f32 v73, v73
    v_mfma_f32_32x32x16_bf16 v[40:55], v[36:39], v[96:99], v[40:55]
    s_mov_b64 exec, s[54:55]
    ds_read_b128 v[32:35], v3 offset:29696
    ds_read_b128 v[36:39], v3 offset:30208
    s_mov_b64 exec, -1
    v_exp_f32 v74, v74
    v_exp_f32 v75, v75
    v_exp_f32 v76, v76
    v_exp_f32 v77, v77
    v_exp_f32 v78, v78
    s_waitcnt lgkmcnt(3)
    v_mfma_f32_32x32x16_bf16 v[88:103], v[20:23], v[12:15], v[56:71]
    ds_read_b128 v[20:23], v1 offset:31744
    v_exp_f32 v79, v79
    v_cvt_pk_bf16_f32 v72, v72, v73
    v_cvt_pk_bf16_f32 v73, v74, v75
    v_cvt_pk_bf16_f32 v74, v76, v77
    v_cvt_pk_bf16_f32 v75, v78, v79
    v_exp_f32 v80, v80
    v_exp_f32 v81, v81
    v_mfma_f32_32x32x16_bf16 v[40:55], v[24:27], v[72:75], v[40:55]
    v_exp_f32 v82, v82
    v_exp_f32 v83, v83
    v_exp_f32 v84, v84
    v_exp_f32 v85, v85
    v_exp_f32 v86, v86
    v_exp_f32 v87, v87
    v_cvt_pk_bf16_f32 v80, v80, v81
    v_cvt_pk_bf16_f32 v81, v82, v83
    v_cvt_pk_bf16_f32 v82, v84, v85
    v_cvt_pk_bf16_f32 v83, v86, v87
    s_setprio 2
    v_exp_f32 v88, v88
    v_exp_f32 v89, v89
    v_mfma_f32_32x32x16_bf16 v[40:55], v[28:31], v[80:83], v[40:55]
    s_mov_b64 exec, s[54:55]
    ds_read_b128 v[24:27], v3 offset:30720
    ds_read_b128 v[28:31], v3 offset:31232
    s_mov_b64 exec, -1
    v_exp_f32 v90, v90
    v_exp_f32 v91, v91
    v_exp_f32 v92, v92
    s_and_b32 exec_lo, s63, 0x3ff800
    s_mov_b32 exec_hi, 0x0
    s_or_b32 exec_hi, exec_hi, 1
    buffer_load_dword v116, v114, s[24:27], 0 offen
    s_mov_b64 exec, -1
    v_exp_f32 v93, v93
    v_exp_f32 v94, v94
    s_waitcnt lgkmcnt(3)
    v_mfma_f32_32x32x16_bf16 v[72:87], v[16:19], v[12:15], v[56:71]
    ds_read_b128 v[16:19], v1 offset:32768
    v_exp_f32 v95, v95
    v_cvt_pk_bf16_f32 v88, v88, v89
    v_cvt_pk_bf16_f32 v89, v90, v91
    v_cvt_pk_bf16_f32 v90, v92, v93
    v_cvt_pk_bf16_f32 v91, v94, v95
    v_exp_f32 v96, v96
    v_exp_f32 v97, v97
    v_mfma_f32_32x32x16_bf16 v[40:55], v[32:35], v[88:91], v[40:55]
    v_exp_f32 v98, v98
    v_exp_f32 v99, v99
    v_exp_f32 v100, v100
    v_exp_f32 v101, v101
    v_exp_f32 v102, v102
    v_exp_f32 v103, v103
    v_cvt_pk_bf16_f32 v96, v96, v97
    v_cvt_pk_bf16_f32 v97, v98, v99
    v_cvt_pk_bf16_f32 v98, v100, v101
    v_cvt_pk_bf16_f32 v99, v102, v103
    v_exp_f32 v72, v72
    v_exp_f32 v73, v73
    v_mfma_f32_32x32x16_bf16 v[40:55], v[36:39], v[96:99], v[40:55]
    s_mov_b64 exec, s[54:55]
    ds_read_b128 v[32:35], v3 offset:31744
    ds_read_b128 v[36:39], v3 offset:32256
    s_mov_b64 exec, -1
    v_exp_f32 v74, v74
    v_exp_f32 v75, v75
    v_exp_f32 v76, v76
    v_exp_f32 v77, v77
    v_exp_f32 v78, v78
    s_waitcnt lgkmcnt(3)
    v_mfma_f32_32x32x16_bf16 v[88:103], v[20:23], v[12:15], v[56:71]
    ds_read_b128 v[20:23], v1 offset:33792
    v_exp_f32 v79, v79
    v_cvt_pk_bf16_f32 v72, v72, v73
    v_cvt_pk_bf16_f32 v73, v74, v75
    v_cvt_pk_bf16_f32 v74, v76, v77
    v_cvt_pk_bf16_f32 v75, v78, v79
    v_exp_f32 v80, v80
    v_exp_f32 v81, v81
    v_mfma_f32_32x32x16_bf16 v[40:55], v[24:27], v[72:75], v[40:55]
    v_exp_f32 v82, v82
    v_exp_f32 v83, v83
    v_exp_f32 v84, v84
    v_exp_f32 v85, v85
    v_exp_f32 v86, v86
    v_exp_f32 v87, v87
    v_cvt_pk_bf16_f32 v80, v80, v81
    v_cvt_pk_bf16_f32 v81, v82, v83
    v_cvt_pk_bf16_f32 v82, v84, v85
    v_cvt_pk_bf16_f32 v83, v86, v87
    v_exp_f32 v88, v88
    v_exp_f32 v89, v89
    v_mfma_f32_32x32x16_bf16 v[40:55], v[28:31], v[80:83], v[40:55]
    s_mov_b64 exec, s[54:55]
    ds_read_b128 v[24:27], v3 offset:32768
    ds_read_b128 v[28:31], v3 offset:33280
    s_mov_b64 exec, -1
    v_exp_f32 v90, v90
    v_exp_f32 v91, v91
    v_exp_f32 v92, v92
    s_and_b32 exec_lo, s63, 0xffc00000
    s_mov_b32 exec_hi, 0x0
    s_or_b32 exec_hi, exec_hi, 1
    buffer_load_dword v117, v114, s[24:27], 0 offen
    s_mov_b64 exec, -1
    v_exp_f32 v93, v93
    v_exp_f32 v94, v94
    s_waitcnt lgkmcnt(3)
    v_mfma_f32_32x32x16_bf16 v[72:87], v[16:19], v[12:15], v[56:71]
    ds_read_b128 v[16:19], v1 offset:34816
    v_exp_f32 v95, v95
    v_cvt_pk_bf16_f32 v88, v88, v89
    v_cvt_pk_bf16_f32 v89, v90, v91
    v_cvt_pk_bf16_f32 v90, v92, v93
    v_cvt_pk_bf16_f32 v91, v94, v95
    v_exp_f32 v96, v96
    v_exp_f32 v97, v97
    v_mfma_f32_32x32x16_bf16 v[40:55], v[32:35], v[88:91], v[40:55]
    v_exp_f32 v98, v98
    v_exp_f32 v99, v99
    v_exp_f32 v100, v100
    v_exp_f32 v101, v101
    v_exp_f32 v102, v102
    v_exp_f32 v103, v103
    v_cvt_pk_bf16_f32 v96, v96, v97
    v_cvt_pk_bf16_f32 v97, v98, v99
    v_cvt_pk_bf16_f32 v98, v100, v101
    v_cvt_pk_bf16_f32 v99, v102, v103
    v_exp_f32 v72, v72
    v_exp_f32 v73, v73
    v_mfma_f32_32x32x16_bf16 v[40:55], v[36:39], v[96:99], v[40:55]
    s_mov_b64 exec, s[54:55]
    ds_read_b128 v[32:35], v3 offset:33792
    ds_read_b128 v[36:39], v3 offset:34304
    s_mov_b64 exec, -1
    v_exp_f32 v74, v74
    v_exp_f32 v75, v75
    v_exp_f32 v76, v76
    v_exp_f32 v77, v77
    v_exp_f32 v78, v78
    s_waitcnt lgkmcnt(3)
    v_mfma_f32_32x32x16_bf16 v[88:103], v[20:23], v[12:15], v[56:71]
    ds_read_b128 v[20:23], v1 offset:35840
    v_exp_f32 v79, v79
    v_cvt_pk_bf16_f32 v72, v72, v73
    v_cvt_pk_bf16_f32 v73, v74, v75
    v_cvt_pk_bf16_f32 v74, v76, v77
    v_cvt_pk_bf16_f32 v75, v78, v79
    v_exp_f32 v80, v80
    v_exp_f32 v81, v81
    v_mfma_f32_32x32x16_bf16 v[40:55], v[24:27], v[72:75], v[40:55]
    v_exp_f32 v82, v82
    v_exp_f32 v83, v83
    v_exp_f32 v84, v84
    v_exp_f32 v85, v85
    v_exp_f32 v86, v86
    v_exp_f32 v87, v87
    v_cvt_pk_bf16_f32 v80, v80, v81
    v_cvt_pk_bf16_f32 v81, v82, v83
    v_cvt_pk_bf16_f32 v82, v84, v85
    v_cvt_pk_bf16_f32 v83, v86, v87
    v_exp_f32 v88, v88
    v_exp_f32 v89, v89
    v_mfma_f32_32x32x16_bf16 v[40:55], v[28:31], v[80:83], v[40:55]
    s_mov_b64 exec, s[54:55]
    ds_read_b128 v[24:27], v3 offset:34816
    ds_read_b128 v[28:31], v3 offset:35328
    s_mov_b64 exec, -1
    v_exp_f32 v90, v90
    v_exp_f32 v91, v91
    v_exp_f32 v92, v92
    s_mov_b32 exec_lo, 0
    s_mov_b32 exec_hi, 0x3ff
    buffer_load_dword v118, v114, s[24:27], 0 offen
    s_mov_b64 exec, -1
    v_exp_f32 v93, v93
    v_exp_f32 v94, v94
    s_waitcnt lgkmcnt(3)
    v_mfma_f32_32x32x16_bf16 v[72:87], v[16:19], v[12:15], v[56:71]
    ds_read_b128 v[16:19], v1 offset:36864
    v_exp_f32 v95, v95
    v_cvt_pk_bf16_f32 v88, v88, v89
    v_cvt_pk_bf16_f32 v89, v90, v91
    v_cvt_pk_bf16_f32 v90, v92, v93
    v_cvt_pk_bf16_f32 v91, v94, v95
    v_exp_f32 v96, v96
    v_exp_f32 v97, v97
    v_mfma_f32_32x32x16_bf16 v[40:55], v[32:35], v[88:91], v[40:55]
    v_exp_f32 v98, v98
    v_exp_f32 v99, v99
    v_exp_f32 v100, v100
    v_exp_f32 v101, v101
    v_exp_f32 v102, v102
    v_exp_f32 v103, v103
    v_cvt_pk_bf16_f32 v96, v96, v97
    v_cvt_pk_bf16_f32 v97, v98, v99
    v_cvt_pk_bf16_f32 v98, v100, v101
    v_cvt_pk_bf16_f32 v99, v102, v103
    v_exp_f32 v72, v72
    v_exp_f32 v73, v73
    v_mfma_f32_32x32x16_bf16 v[40:55], v[36:39], v[96:99], v[40:55]
    s_mov_b64 exec, s[54:55]
    ds_read_b128 v[32:35], v3 offset:35840
    ds_read_b128 v[36:39], v3 offset:36352
    s_mov_b64 exec, -1
    v_exp_f32 v74, v74
    v_exp_f32 v75, v75
    v_exp_f32 v76, v76
    v_exp_f32 v77, v77
    v_exp_f32 v78, v78
    s_waitcnt lgkmcnt(3)
    v_mfma_f32_32x32x16_bf16 v[88:103], v[20:23], v[12:15], v[56:71]
    ds_read_b128 v[20:23], v1 offset:37888
    v_exp_f32 v79, v79
    v_cvt_pk_bf16_f32 v72, v72, v73
    v_cvt_pk_bf16_f32 v73, v74, v75
    v_cvt_pk_bf16_f32 v74, v76, v77
    v_cvt_pk_bf16_f32 v75, v78, v79
    v_exp_f32 v80, v80
    v_exp_f32 v81, v81
    v_mfma_f32_32x32x16_bf16 v[40:55], v[24:27], v[72:75], v[40:55]
    v_exp_f32 v82, v82
    v_exp_f32 v83, v83
    v_exp_f32 v84, v84
    v_exp_f32 v85, v85
    v_exp_f32 v86, v86
    v_exp_f32 v87, v87
    v_cvt_pk_bf16_f32 v80, v80, v81
    v_cvt_pk_bf16_f32 v81, v82, v83
    v_cvt_pk_bf16_f32 v82, v84, v85
    v_cvt_pk_bf16_f32 v83, v86, v87
    s_setprio 1
    v_exp_f32 v88, v88
    v_exp_f32 v89, v89
    v_mfma_f32_32x32x16_bf16 v[40:55], v[28:31], v[80:83], v[40:55]
    s_mov_b64 exec, s[54:55]
    ds_read_b128 v[24:27], v3 offset:36864
    ds_read_b128 v[28:31], v3 offset:37376
    s_mov_b64 exec, -1
    v_exp_f32 v90, v90
    v_exp_f32 v91, v91
    v_exp_f32 v92, v92
    v_exp_f32 v93, v93
    v_exp_f32 v94, v94
    s_waitcnt lgkmcnt(3)
    v_mfma_f32_32x32x16_bf16 v[72:87], v[16:19], v[12:15], v[56:71]
    ds_read_b128 v[16:19], v1 offset:38912
    v_exp_f32 v95, v95
    v_cvt_pk_bf16_f32 v88, v88, v89
    v_cvt_pk_bf16_f32 v89, v90, v91
    v_cvt_pk_bf16_f32 v90, v92, v93
    v_cvt_pk_bf16_f32 v91, v94, v95
    v_exp_f32 v96, v96
    v_exp_f32 v97, v97
    v_mfma_f32_32x32x16_bf16 v[40:55], v[32:35], v[88:91], v[40:55]
    v_exp_f32 v98, v98
    v_exp_f32 v99, v99
    v_exp_f32 v100, v100
    v_exp_f32 v101, v101
    v_exp_f32 v102, v102
    v_exp_f32 v103, v103
    v_cvt_pk_bf16_f32 v96, v96, v97
    v_cvt_pk_bf16_f32 v97, v98, v99
    v_cvt_pk_bf16_f32 v98, v100, v101
    v_cvt_pk_bf16_f32 v99, v102, v103
    v_exp_f32 v72, v72
    v_exp_f32 v73, v73
    v_mfma_f32_32x32x16_bf16 v[40:55], v[36:39], v[96:99], v[40:55]
    s_mov_b64 exec, s[54:55]
    ds_read_b128 v[32:35], v3 offset:37888
    ds_read_b128 v[36:39], v3 offset:38400
    s_mov_b64 exec, -1
    v_exp_f32 v74, v74
    v_exp_f32 v75, v75
    v_exp_f32 v76, v76
    v_exp_f32 v77, v77
    v_exp_f32 v78, v78
    s_waitcnt lgkmcnt(3)
    v_mfma_f32_32x32x16_bf16 v[88:103], v[20:23], v[12:15], v[56:71]
    ds_read_b128 v[20:23], v1 offset:39936
    v_exp_f32 v79, v79
    v_cvt_pk_bf16_f32 v72, v72, v73
    v_cvt_pk_bf16_f32 v73, v74, v75
    v_cvt_pk_bf16_f32 v74, v76, v77
    v_cvt_pk_bf16_f32 v75, v78, v79
    v_exp_f32 v80, v80
    v_exp_f32 v81, v81
    v_mfma_f32_32x32x16_bf16 v[40:55], v[24:27], v[72:75], v[40:55]
    v_exp_f32 v82, v82
    v_exp_f32 v83, v83
    v_exp_f32 v84, v84
    v_exp_f32 v85, v85
    v_exp_f32 v86, v86
    v_exp_f32 v87, v87
    v_cvt_pk_bf16_f32 v80, v80, v81
    v_cvt_pk_bf16_f32 v81, v82, v83
    v_cvt_pk_bf16_f32 v82, v84, v85
    v_cvt_pk_bf16_f32 v83, v86, v87
    v_exp_f32 v88, v88
    v_exp_f32 v89, v89
    v_mfma_f32_32x32x16_bf16 v[40:55], v[28:31], v[80:83], v[40:55]
    s_mov_b64 exec, s[54:55]
    ds_read_b128 v[24:27], v3 offset:38912
    ds_read_b128 v[28:31], v3 offset:39424
    s_mov_b64 exec, -1
    v_exp_f32 v90, v90
    v_exp_f32 v91, v91
    v_exp_f32 v92, v92
    v_exp_f32 v93, v93
    v_exp_f32 v94, v94
    s_waitcnt lgkmcnt(3)
    v_mfma_f32_32x32x16_bf16 v[72:87], v[16:19], v[12:15], v[56:71]
    ds_read_b128 v[16:19], v1 offset:40960
    v_exp_f32 v95, v95
    v_cvt_pk_bf16_f32 v88, v88, v89
    v_cvt_pk_bf16_f32 v89, v90, v91
    v_cvt_pk_bf16_f32 v90, v92, v93
    v_cvt_pk_bf16_f32 v91, v94, v95
    v_exp_f32 v96, v96
    v_exp_f32 v97, v97
    v_mfma_f32_32x32x16_bf16 v[40:55], v[32:35], v[88:91], v[40:55]
    v_exp_f32 v98, v98
    v_exp_f32 v99, v99
    v_exp_f32 v100, v100
    v_exp_f32 v101, v101
    v_exp_f32 v102, v102
    v_exp_f32 v103, v103
    v_cvt_pk_bf16_f32 v96, v96, v97
    v_cvt_pk_bf16_f32 v97, v98, v99
    v_cvt_pk_bf16_f32 v98, v100, v101
    v_cvt_pk_bf16_f32 v99, v102, v103
    s_setprio 0
    v_exp_f32 v72, v72
    v_exp_f32 v73, v73
    v_mfma_f32_32x32x16_bf16 v[40:55], v[36:39], v[96:99], v[40:55]
    s_mov_b64 exec, s[54:55]
    ds_read_b128 v[32:35], v3 offset:39936
    ds_read_b128 v[36:39], v3 offset:40448
    s_mov_b64 exec, -1
    v_exp_f32 v74, v74
    v_exp_f32 v75, v75
    v_exp_f32 v76, v76
    v_exp_f32 v77, v77
    v_exp_f32 v78, v78
    s_waitcnt lgkmcnt(3)
    v_mfma_f32_32x32x16_bf16 v[88:103], v[20:23], v[12:15], v[56:71]
    ds_read_b128 v[20:23], v1 offset:41984
    v_exp_f32 v79, v79
    v_cvt_pk_bf16_f32 v72, v72, v73
    v_cvt_pk_bf16_f32 v73, v74, v75
    v_cvt_pk_bf16_f32 v74, v76, v77
    v_cvt_pk_bf16_f32 v75, v78, v79
    v_exp_f32 v80, v80
    v_exp_f32 v81, v81
    v_mfma_f32_32x32x16_bf16 v[40:55], v[24:27], v[72:75], v[40:55]
    v_exp_f32 v82, v82
    v_exp_f32 v83, v83
    v_exp_f32 v84, v84
    v_exp_f32 v85, v85
    v_exp_f32 v86, v86
    v_exp_f32 v87, v87
    v_cvt_pk_bf16_f32 v80, v80, v81
    v_cvt_pk_bf16_f32 v81, v82, v83
    v_cvt_pk_bf16_f32 v82, v84, v85
    v_cvt_pk_bf16_f32 v83, v86, v87
    v_exp_f32 v88, v88
    v_exp_f32 v89, v89
    v_mfma_f32_32x32x16_bf16 v[40:55], v[28:31], v[80:83], v[40:55]
    s_mov_b64 exec, s[54:55]
    ds_read_b128 v[24:27], v3 offset:40960
    ds_read_b128 v[28:31], v3 offset:41472
    s_mov_b64 exec, -1
    v_exp_f32 v90, v90
    v_exp_f32 v91, v91
    v_exp_f32 v92, v92
    v_exp_f32 v93, v93
    v_exp_f32 v94, v94
    s_waitcnt lgkmcnt(3)
    v_mfma_f32_32x32x16_bf16 v[72:87], v[16:19], v[12:15], v[56:71]
    ds_read_b128 v[16:19], v1 offset:43008
    v_exp_f32 v95, v95
    v_cvt_pk_bf16_f32 v88, v88, v89
    v_cvt_pk_bf16_f32 v89, v90, v91
    v_cvt_pk_bf16_f32 v90, v92, v93
    v_cvt_pk_bf16_f32 v91, v94, v95
    v_exp_f32 v96, v96
    v_exp_f32 v97, v97
    v_mfma_f32_32x32x16_bf16 v[40:55], v[32:35], v[88:91], v[40:55]
    v_exp_f32 v98, v98
    v_exp_f32 v99, v99
    v_exp_f32 v100, v100
    v_exp_f32 v101, v101
    v_exp_f32 v102, v102
    v_exp_f32 v103, v103
    v_cvt_pk_bf16_f32 v96, v96, v97
    v_cvt_pk_bf16_f32 v97, v98, v99
    v_cvt_pk_bf16_f32 v98, v100, v101
    v_cvt_pk_bf16_f32 v99, v102, v103
    s_cmp_lg_u32 s22, 0
    s_cbranch_scc1 L_w0_sequen_19
    v_bfe_u32 v2, v1, 4, 5
    s_mul_i32 s48, s4, 14
    v_add_u32 v6, s48, v2
    v_add_u32 v104, 98, v6
    v_cmp_lt_u32 vcc, 13, v2
    s_lshl_b32 s48, s4, 2
    s_add_u32 s48, s48, 196
    v_cndmask_b32 v6, v6, v104, vcc
    v_add_u32 v104, s48, v2
    v_cmp_lt_u32 vcc, 27, v2
    s_mov_b32 s48, 0x1788000
    v_lshrrev_b32 v2, 9, v1
    v_cndmask_b32 v6, v6, v104, vcc
    v_lshlrev_b32 v6, 9, v6
    v_lshl_add_u32 v6, v2, 8, v6
    s_mov_b32 s51, 0
L_sp_sequen_20:
    buffer_load_dwordx2 v[104:105], v6, s[24:27], s48 offen sc1
    buffer_load_dwordx2 v[106:107], v6, s[24:27], s48 offen offset:128 sc1
    s_add_u32 s51, s51, 1
    s_waitcnt vmcnt(0)
    v_cmp_eq_u64 vcc, v[104:105], v[4:5]
    v_cmp_eq_u64 s[56:57], v[106:107], v[4:5]
    s_cmp_gt_u32 s51, 400000
    s_cbranch_scc1 L_spd_sequen_21
    s_and_b64 vcc, vcc, s[56:57]
    s_cmp_eq_u64 vcc, -1
    s_cbranch_scc0 L_sp_sequen_20
L_spd_sequen_21:
L_w0_sequen_19:
    s_barrier
    s_setprio 3
    v_exp_f32 v72, v72
    v_exp_f32 v73, v73
    v_mfma_f32_32x32x16_bf16 v[40:55], v[36:39], v[96:99], v[40:55]
    s_mov_b64 exec, s[54:55]
    ds_read_b128 v[32:35], v3 offset:41984
    ds_read_b128 v[36:39], v3 offset:42496
    s_mov_b64 exec, -1
    v_exp_f32 v74, v74
    v_exp_f32 v75, v75
    v_exp_f32 v76, v76
    v_exp_f32 v77, v77
    v_exp_f32 v78, v78
    s_waitcnt lgkmcnt(3)
    v_mfma_f32_32x32x16_bf16 v[88:103], v[20:23], v[12:15], v[56:71]
    ds_read_b128 v[20:23], v1 offset:44032
    v_exp_f32 v79, v79
    v_cvt_pk_bf16_f32 v72, v72, v73
    v_cvt_pk_bf16_f32 v73, v74, v75
    v_cvt_pk_bf16_f32 v74, v76, v77
    v_cvt_pk_bf16_f32 v75, v78, v79
    v_exp_f32 v80, v80
    v_exp_f32 v81, v81
    v_mfma_f32_32x32x16_bf16 v[40:55], v[24:27], v[72:75], v[40:55]
    v_exp_f32 v82, v82
    v_exp_f32 v83, v83
    v_exp_f32 v84, v84
    v_exp_f32 v85, v85
    v_exp_f32 v86, v86
    v_exp_f32 v87, v87
    v_cvt_pk_bf16_f32 v80, v80, v81
    v_cvt_pk_bf16_f32 v81, v82, v83
    v_cvt_pk_bf16_f32 v82, v84, v85
    v_cvt_pk_bf16_f32 v83, v86, v87
    v_exp_f32 v88, v88
    v_exp_f32 v89, v89
    v_mfma_f32_32x32x16_bf16 v[40:55], v[28:31], v[80:83], v[40:55]
    s_mov_b64 exec, s[54:55]
    ds_read_b128 v[24:27], v3 offset:43008
    ds_read_b128 v[28:31], v3 offset:43520
    s_mov_b64 exec, -1
    v_exp_f32 v90, v90
    v_exp_f32 v91, v91
    v_exp_f32 v92, v92
    buffer_load_dwordx4 v[128:131], v1, s[24:27], s13 offen sc1
    s_add_u32 s13, s13, s15
    buffer_load_dwordx4 v[132:135], v1, s[24:27], s14 offen sc1
    s_add_u32 s14, s14, s15
    v_exp_f32 v93, v93
    v_exp_f32 v94, v94
    s_waitcnt lgkmcnt(3)
    v_mfma_f32_32x32x16_bf16 v[72:87], v[16:19], v[12:15], v[56:71]
    ds_read_b128 v[16:19], v1 offset:45056
    v_exp_f32 v95, v95
    v_cvt_pk_bf16_f32 v88, v88, v89
    v_cvt_pk_bf16_f32 v89, v90, v91
    v_cvt_pk_bf16_f32 v90, v92, v93
    v_cvt_pk_bf16_f32 v91, v94, v95
    v_exp_f32 v96, v96
    v_exp_f32 v97, v97
    v_mfma_f32_32x32x16_bf16 v[40:55], v[32:35], v[88:91], v[40:55]
    v_exp_f32 v98, v98
    v_exp_f32 v99, v99
    v_exp_f32 v100, v100
    v_exp_f32 v101, v101
    v_exp_f32 v102, v102
    v_exp_f32 v103, v103
    v_cvt_pk_bf16_f32 v96, v96, v97
    v_cvt_pk_bf16_f32 v97, v98, v99
    v_cvt_pk_bf16_f32 v98, v100, v101
    v_cvt_pk_bf16_f32 v99, v102, v103
    v_exp_f32 v72, v72
    v_exp_f32 v73, v73
    v_mfma_f32_32x32x16_bf16 v[40:55], v[36:39], v[96:99], v[40:55]
    s_mov_b64 exec, s[54:55]
    ds_read_b128 v[32:35], v3 offset:44032
    ds_read_b128 v[36:39], v3 offset:44544
    s_mov_b64 exec, -1
    v_exp_f32 v74, v74
    v_exp_f32 v75, v75
    v_exp_f32 v76, v76
    buffer_load_dwordx4 v[136:139], v1, s[24:27], s13 offen sc1
    s_add_u32 s13, s13, s15
    s_add_u32 m0, s19, 0
    s_add_u32 s49, s20, 0
    buffer_load_dwordx4 v1, s[24:27], s49 offen sc1 lds
    v_exp_f32 v77, v77
    v_exp_f32 v78, v78
    s_waitcnt lgkmcnt(3)
    v_mfma_f32_32x32x16_bf16 v[88:103], v[20:23], v[12:15], v[56:71]
    ds_read_b128 v[20:23], v1 offset:46080
    v_exp_f32 v79, v79
    v_cvt_pk_bf16_f32 v72, v72, v73
    v_cvt_pk_bf16_f32 v73, v74, v75
    v_cvt_pk_bf16_f32 v74, v76, v77
    v_cvt_pk_bf16_f32 v75, v78, v79
    v_exp_f32 v80, v80
    v_exp_f32 v81, v81
    v_mfma_f32_32x32x16_bf16 v[40:55], v[24:27], v[72:75], v[40:55]
    v_exp_f32 v82, v82
    v_exp_f32 v83, v83
    v_exp_f32 v84, v84
    v_exp_f32 v85, v85
    v_exp_f32 v86, v86
    v_exp_f32 v87, v87
    v_cvt_pk_bf16_f32 v80, v80, v81
    v_cvt_pk_bf16_f32 v81, v82, v83
    v_cvt_pk_bf16_f32 v82, v84, v85
    v_cvt_pk_bf16_f32 v83, v86, v87
    v_exp_f32 v88, v88
    v_exp_f32 v89, v89
    v_mfma_f32_32x32x16_bf16 v[40:55], v[28:31], v[80:83], v[40:55]
    s_mov_b64 exec, s[54:55]
    ds_read_b128 v[24:27], v3 offset:45056
    ds_read_b128 v[28:31], v3 offset:45568
    s_mov_b64 exec, -1
    v_exp_f32 v90, v90
    v_exp_f32 v91, v91
    v_exp_f32 v92, v92
    buffer_load_dwordx4 v[140:143], v1, s[24:27], s14 offen sc1
    s_add_u32 s14, s14, s15
    buffer_load_dwordx4 v[144:147], v1, s[24:27], s13 offen sc1
    s_add_u32 s13, s13, s15
    v_exp_f32 v93, v93
    v_exp_f32 v94, v94
    s_waitcnt lgkmcnt(3)
    v_mfma_f32_32x32x16_bf16 v[72:87], v[16:19], v[12:15], v[56:71]
    ds_read_b128 v[16:19], v1 offset:47104
    v_exp_f32 v95, v95
    v_cvt_pk_bf16_f32 v88, v88, v89
    v_cvt_pk_bf16_f32 v89, v90, v91
    v_cvt_pk_bf16_f32 v90, v92, v93
    v_cvt_pk_bf16_f32 v91, v94, v95
    v_exp_f32 v96, v96
    v_exp_f32 v97, v97
    v_mfma_f32_32x32x16_bf16 v[40:55], v[32:35], v[88:91], v[40:55]
    v_exp_f32 v98, v98
    v_exp_f32 v99, v99
    v_exp_f32 v100, v100
    v_exp_f32 v101, v101
    v_exp_f32 v102, v102
    v_exp_f32 v103, v103
    v_cvt_pk_bf16_f32 v96, v96, v97
    v_cvt_pk_bf16_f32 v97, v98, v99
    v_cvt_pk_bf16_f32 v98, v100, v101
    v_cvt_pk_bf16_f32 v99, v102, v103
    v_exp_f32 v72, v72
    v_exp_f32 v73, v73
    v_mfma_f32_32x32x16_bf16 v[40:55], v[36:39], v[96:99], v[40:55]
    s_mov_b64 exec, s[54:55]
    ds_read_b128 v[32:35], v3 offset:46080
    ds_read_b128 v[36:39], v3 offset:46592
    s_mov_b64 exec, -1
    v_exp_f32 v74, v74
    v_exp_f32 v75, v75
    v_exp_f32 v76, v76
    buffer_load_dwordx4 v[148:151], v1, s[24:27], s14 offen sc1
    s_add_u32 s14, s14, s15
    s_add_u32 m0, s19, 1024
    s_add_u32 s49, s20, 1024
    buffer_load_dwordx4 v1, s[24:27], s49 offen sc1 lds
    v_exp_f32 v77, v77
    v_exp_f32 v78, v78
    s_waitcnt lgkmcnt(3)
    v_mfma_f32_32x32x16_bf16 v[88:103], v[20:23], v[12:15], v[56:71]
    ds_read_b128 v[20:23], v1 offset:48128
    v_exp_f32 v79, v79
    v_cvt_pk_bf16_f32 v72, v72, v73
    v_cvt_pk_bf16_f32 v73, v74, v75
    v_cvt_pk_bf16_f32 v74, v76, v77
    v_cvt_pk_bf16_f32 v75, v78, v79
    v_exp_f32 v80, v80
    v_exp_f32 v81, v81
    v_mfma_f32_32x32x16_bf16 v[40:55], v[24:27], v[72:75], v[40:55]
    v_exp_f32 v82, v82
    v_exp_f32 v83, v83
    v_exp_f32 v84, v84
    v_exp_f32 v85, v85
    v_exp_f32 v86, v86
    v_exp_f32 v87, v87
    v_cvt_pk_bf16_f32 v80, v80, v81
    v_cvt_pk_bf16_f32 v81, v82, v83
    v_cvt_pk_bf16_f32 v82, v84, v85
    v_cvt_pk_bf16_f32 v83, v86, v87
    v_exp_f32 v88, v88
    v_exp_f32 v89, v89
    v_mfma_f32_32x32x16_bf16 v[40:55], v[28:31], v[80:83], v[40:55]
    s_mov_b64 exec, s[54:55]
    ds_read_b128 v[24:27], v3 offset:47104
    ds_read_b128 v[28:31], v3 offset:47616
    s_mov_b64 exec, -1
    v_exp_f32 v90, v90
    v_exp_f32 v91, v91
    v_exp_f32 v92, v92
    buffer_load_dwordx4 v[152:155], v1, s[24:27], s13 offen sc1
    s_add_u32 s13, s13, s15
    buffer_load_dwordx4 v[156:159], v1, s[24:27], s14 offen sc1
    s_add_u32 s14, s14, s15
    v_exp_f32 v93, v93
    v_exp_f32 v94, v94
    s_waitcnt lgkmcnt(3)
    v_mfma_f32_32x32x16_bf16 v[72:87], v[16:19], v[12:15], v[56:71]
    ds_read_b128 v[16:19], v1 offset:49152
    v_exp_f32 v95, v95
    v_cvt_pk_bf16_f32 v88, v88, v89
    v_cvt_pk_bf16_f32 v89, v90, v91
    v_cvt_pk_bf16_f32 v90, v92, v93
    v_cvt_pk_bf16_f32 v91, v94, v95
    v_exp_f32 v96, v96
    v_exp_f32 v97, v97
    v_mfma_f32_32x32x16_bf16 v[40:55], v[32:35], v[88:91], v[40:55]
    v_exp_f32 v98, v98
    v_exp_f32 v99, v99
    v_exp_f32 v100, v100
    v_exp_f32 v101, v101
    v_exp_f32 v102, v102
    v_exp_f32 v103, v103
    v_cvt_pk_bf16_f32 v96, v96, v97
    v_cvt_pk_bf16_f32 v97, v98, v99
    v_cvt_pk_bf16_f32 v98, v100, v101
    v_cvt_pk_bf16_f32 v99, v102, v103
    v_exp_f32 v72, v72
    v_exp_f32 v73, v73
    v_mfma_f32_32x32x16_bf16 v[40:55], v[36:39], v[96:99], v[40:55]
    s_mov_b64 exec, s[54:55]
    ds_read_b128 v[32:35], v3 offset:48128
    ds_read_b128 v[36:39], v3 offset:48640
    s_mov_b64 exec, -1
    v_exp_f32 v74, v74
    v_exp_f32 v75, v75
    v_exp_f32 v76, v76
    buffer_load_dwordx4 v[160:163], v1, s[24:27], s13 offen sc1
    s_add_u32 s13, s13, s15
    v_exp_f32 v77, v77
    v_exp_f32 v78, v78
    s_waitcnt lgkmcnt(3)
    v_mfma_f32_32x32x16_bf16 v[88:103], v[20:23], v[12:15], v[56:71]
    ds_read_b128 v[20:23], v1 offset:50176
    v_exp_f32 v79, v79
    v_cvt_pk_bf16_f32 v72, v72, v73
    v_cvt_pk_bf16_f32 v73, v74, v75
    v_cvt_pk_bf16_f32 v74, v76, v77
    v_cvt_pk_bf16_f32 v75, v78, v79
    v_exp_f32 v80, v80
    v_exp_f32 v81, v81
    v_mfma_f32_32x32x16_bf16 v[40:55], v[24:27], v[72:75], v[40:55]
    v_exp_f32 v82, v82
    v_exp_f32 v83, v83
    v_exp_f32 v84, v84
    v_exp_f32 v85, v85
    v_exp_f32 v86, v86
    v_exp_f32 v87, v87
    v_cvt_pk_bf16_f32 v80, v80, v81
    v_cvt_pk_bf16_f32 v81, v82, v83
    v_cvt_pk_bf16_f32 v82, v84, v85
    v_cvt_pk_bf16_f32 v83, v86, v87
    v_exp_f32 v88, v88
    v_exp_f32 v89, v89
    v_mfma_f32_32x32x16_bf16 v[40:55], v[28:31], v[80:83], v[40:55]
    s_mov_b64 exec, s[54:55]
    ds_read_b128 v[24:27], v3 offset:49152
    ds_read_b128 v[28:31], v3 offset:49664
    s_mov_b64 exec, -1
    v_exp_f32 v90, v90
    v_exp_f32 v91, v91
    v_exp_f32 v92, v92
    buffer_load_dwordx4 v[164:167], v1, s[24:27], s14 offen sc1
    s_add_u32 s14, s14, s15
    buffer_load_dwordx4 v[168:171], v1, s[24:27], s13 offen sc1
    s_add_u32 s13, s13, s15
    s_add_u32 m0, s19, 2048
    s_add_u32 s49, s20, 2048
    buffer_load_dwordx4 v1, s[24:27], s49 offen sc1 lds
    v_exp_f32 v93, v93
    v_exp_f32 v94, v94
    s_waitcnt lgkmcnt(3)
    v_mfma_f32_32x32x16_bf16 v[72:87], v[16:19], v[12:15], v[56:71]
    ds_read_b128 v[16:19], v1 offset:51200
    v_exp_f32 v95, v95
    v_cvt_pk_bf16_f32 v88, v88, v89
    v_cvt_pk_bf16_f32 v89, v90, v91
    v_cvt_pk_bf16_f32 v90, v92, v93
    v_cvt_pk_bf16_f32 v91, v94, v95
    v_exp_f32 v96, v96
    v_exp_f32 v97, v97
    v_mfma_f32_32x32x16_bf16 v[40:55], v[32:35], v[88:91], v[40:55]
    v_exp_f32 v98, v98
    v_exp_f32 v99, v99
    v_exp_f32 v100, v100
    v_exp_f32 v101, v101
    v_exp_f32 v102, v102
    v_exp_f32 v103, v103
    v_cvt_pk_bf16_f32 v96, v96, v97
    v_cvt_pk_bf16_f32 v97, v98, v99
    v_cvt_pk_bf16_f32 v98, v100, v101
    v_cvt_pk_bf16_f32 v99, v102, v103
    v_exp_f32 v72, v72
    v_exp_f32 v73, v73
    v_mfma_f32_32x32x16_bf16 v[40:55], v[36:39], v[96:99], v[40:55]
    s_mov_b64 exec, s[54:55]
    ds_read_b128 v[32:35], v3 offset:50176
    ds_read_b128 v[36:39], v3 offset:50688
    s_mov_b64 exec, -1
    v_exp_f32 v74, v74
    v_exp_f32 v75, v75
    v_exp_f32 v76, v76
    buffer_load_dwordx4 v[172:175], v1, s[24:27], s14 offen sc1
    s_add_u32 s14, s14, s15
    v_exp_f32 v77, v77
    v_exp_f32 v78, v78
    s_waitcnt lgkmcnt(3)
    v_mfma_f32_32x32x16_bf16 v[88:103], v[20:23], v[12:15], v[56:71]
    ds_read_b128 v[20:23], v1 offset:52224
    v_exp_f32 v79, v79
    v_cvt_pk_bf16_f32 v72, v72, v73
    v_cvt_pk_bf16_f32 v73, v74, v75
    v_cvt_pk_bf16_f32 v74, v76, v77
    v_cvt_pk_bf16_f32 v75, v78, v79
    v_exp_f32 v80, v80
    v_exp_f32 v81, v81
    v_mfma_f32_32x32x16_bf16 v[40:55], v[24:27], v[72:75], v[40:55]
    v_exp_f32 v82, v82
    v_exp_f32 v83, v83
    v_exp_f32 v84, v84
    v_exp_f32 v85, v85
    v_exp_f32 v86, v86
    v_exp_f32 v87, v87
    v_cvt_pk_bf16_f32 v80, v80, v81
    v_cvt_pk_bf16_f32 v81, v82, v83
    v_cvt_pk_bf16_f32 v82, v84, v85
    v_cvt_pk_bf16_f32 v83, v86, v87
    v_exp_f32 v88, v88
    v_exp_f32 v89, v89
    v_mfma_f32_32x32x16_bf16 v[40:55], v[28:31], v[80:83], v[40:55]
    s_mov_b64 exec, s[54:55]
    ds_read_b128 v[24:27], v3 offset:51200
    ds_read_b128 v[28:31], v3 offset:51712
    s_mov_b64 exec, -1
    v_exp_f32 v90, v90
    v_exp_f32 v91, v91
    v_exp_f32 v92, v92
    buffer_load_dwordx4 v[176:179], v1, s[24:27], s13 offen sc1
    s_add_u32 s13, s13, s15
    buffer_load_dwordx4 v[180:183], v1, s[24:27], s14 offen sc1
    s_add_u32 s14, s14, s15
    s_add_u32 m0, s19, 3072
    s_add_u32 s49, s20, 3072
    buffer_load_dwordx4 v1, s[24:27], s49 offen sc1 lds
    v_exp_f32 v93, v93
    v_exp_f32 v94, v94
    s_waitcnt lgkmcnt(3)
    v_mfma_f32_32x32x16_bf16 v[72:87], v[16:19], v[12:15], v[56:71]
    ds_read_b128 v[16:19], v1 offset:53248
    v_exp_f32 v95, v95
    v_cvt_pk_bf16_f32 v88, v88, v89
    v_cvt_pk_bf16_f32 v89, v90, v91
    v_cvt_pk_bf16_f32 v90, v92, v93
    v_cvt_pk_bf16_f32 v91, v94, v95
    v_exp_f32 v96, v96
    v_exp_f32 v97, v97
    v_mfma_f32_32x32x16_bf16 v[40:55], v[32:35], v[88:91], v[40:55]
    v_exp_f32 v98, v98
    v_exp_f32 v99, v99
    v_exp_f32 v100, v100
    v_exp_f32 v101, v101
    v_exp_f32 v102, v102
    v_exp_f32 v103, v103
    v_cvt_pk_bf16_f32 v96, v96, v97
    v_cvt_pk_bf16_f32 v97, v98, v99
    v_cvt_pk_bf16_f32 v98, v100, v101
    v_cvt_pk_bf16_f32 v99, v102, v103
    v_exp_f32 v72, v72
    v_exp_f32 v73, v73
    v_mfma_f32_32x32x16_bf16 v[40:55], v[36:39], v[96:99], v[40:55]
    s_mov_b64 exec, s[54:55]
    ds_read_b128 v[32:35], v3 offset:52224
    ds_read_b128 v[36:39], v3 offset:52736
    s_mov_b64 exec, -1
    v_exp_f32 v74, v74
    v_exp_f32 v75, v75
    v_exp_f32 v76, v76
    buffer_load_dwordx4 v[184:187], v1, s[24:27], s13 offen sc1
    s_add_u32 s13, s13, s15
    v_exp_f32 v77, v77
    v_exp_f32 v78, v78
    s_waitcnt lgkmcnt(3)
    v_mfma_f32_32x32x16_bf16 v[88:103], v[20:23], v[12:15], v[56:71]
    ds_read_b128 v[20:23], v1 offset:54272
    v_exp_f32 v79, v79
    v_cvt_pk_bf16_f32 v72, v72, v73
    v_cvt_pk_bf16_f32 v73, v74, v75
    v_cvt_pk_bf16_f32 v74, v76, v77
    v_cvt_pk_bf16_f32 v75, v78, v79
    v_exp_f32 v80, v80
    v_exp_f32 v81, v81
    v_mfma_f32_32x32x16_bf16 v[40:55], v[24:27], v[72:75], v[40:55]
    v_exp_f32 v82, v82
    v_exp_f32 v83, v83
    v_exp_f32 v84, v84
    v_exp_f32 v85, v85
    v_exp_f32 v86, v86
    v_exp_f32 v87, v87
    v_cvt_pk_bf16_f32 v80, v80, v81
    v_cvt_pk_bf16_f32 v81, v82, v83
    v_cvt_pk_bf16_f32 v82, v84, v85
    v_cvt_pk_bf16_f32 v83, v86, v87
    v_exp_f32 v88, v88
    v_exp_f32 v89, v89
    v_mfma_f32_32x32x16_bf16 v[40:55], v[28:31], v[80:83], v[40:55]
    s_mov_b64 exec, s[54:55]
    ds_read_b128 v[24:27], v3 offset:53248
    ds_read_b128 v[28:31], v3 offset:53760
    s_mov_b64 exec, -1
    v_exp_f32 v90, v90
    v_exp_f32 v91, v91
    v_exp_f32 v92, v92
    buffer_load_dwordx4 v[188:191], v1, s[24:27], s14 offen sc1
    s_add_u32 s14, s14, s15
    v_exp_f32 v93, v93
    v_exp_f32 v94, v94
    s_waitcnt lgkmcnt(3)
    v_mfma_f32_32x32x16_bf16 v[72:87], v[16:19], v[12:15], v[56:71]
    ds_read_b128 v[16:19], v1 offset:55296
    v_exp_f32 v95, v95
    v_cvt_pk_bf16_f32 v88, v88, v89
    v_cvt_pk_bf16_f32 v89, v90, v91
    v_cvt_pk_bf16_f32 v90, v92, v93
    v_cvt_pk_bf16_f32 v91, v94, v95
    v_exp_f32 v96, v96
    v_exp_f32 v97, v97
    v_mfma_f32_32x32x16_bf16 v[40:55], v[32:35], v[88:91], v[40:55]
    v_exp_f32 v98, v98
    v_exp_f32 v99, v99
    v_exp_f32 v100, v100
    v_exp_f32 v101, v101
    v_exp_f32 v102, v102
    v_exp_f32 v103, v103
    v_cvt_pk_bf16_f32 v96, v96, v97
    v_cvt_pk_bf16_f32 v97, v98, v99
    v_cvt_pk_bf16_f32 v98, v100, v101
    v_cvt_pk_bf16_f32 v99, v102, v103
    v_exp_f32 v72, v72
    v_exp_f32 v73, v73
    v_mfma_f32_32x32x16_bf16 v[40:55], v[36:39], v[96:99], v[40:55]
    s_mov_b64 exec, s[54:55]
    ds_read_b128 v[32:35], v3 offset:54272
    ds_read_b128 v[36:39], v3 offset:54784
    s_mov_b64 exec, -1
    v_exp_f32 v74, v74
    v_exp_f32 v75, v75
    v_exp_f32 v76, v76
    buffer_load_dwordx4 v[192:195], v1, s[24:27], s13 offen sc1
    s_add_u32 s13, s13, s15
    buffer_load_dwordx4 v[196:199], v1, s[24:27], s14 offen sc1
    s_add_u32 s14, s14, s15
    s_add_u32 m0, s19, 65536
    s_add_u32 s49, s20, 32768
    buffer_load_dwordx4 v1, s[24:27], s49 offen sc1 lds
    v_exp_f32 v77, v77
    v_exp_f32 v78, v78
    s_waitcnt lgkmcnt(3)
    v_mfma_f32_32x32x16_bf16 v[88:103], v[20:23], v[12:15], v[56:71]
    ds_read_b128 v[20:23], v1 offset:56320
    v_exp_f32 v79, v79
    v_cvt_pk_bf16_f32 v72, v72, v73
    v_cvt_pk_bf16_f32 v73, v74, v75
    v_cvt_pk_bf16_f32 v74, v76, v77
    v_cvt_pk_bf16_f32 v75, v78, v79
    v_exp_f32 v80, v80
    v_exp_f32 v81, v81
    v_mfma_f32_32x32x16_bf16 v[40:55], v[24:27], v[72:75], v[40:55]
    v_exp_f32 v82, v82
    v_exp_f32 v83, v83
    v_exp_f32 v84, v84
    v_exp_f32 v85, v85
    v_exp_f32 v86, v86
    v_exp_f32 v87, v87
    v_cvt_pk_bf16_f32 v80, v80, v81
    v_cvt_pk_bf16_f32 v81, v82, v83
    v_cvt_pk_bf16_f32 v82, v84, v85
    v_cvt_pk_bf16_f32 v83, v86, v87
    v_exp_f32 v88, v88
    v_exp_f32 v89, v89
    v_mfma_f32_32x32x16_bf16 v[40:55], v[28:31], v[80:83], v[40:55]
    s_mov_b64 exec, s[54:55]
    ds_read_b128 v[24:27], v3 offset:55296
    ds_read_b128 v[28:31], v3 offset:55808
    s_mov_b64 exec, -1
    v_exp_f32 v90, v90
    v_exp_f32 v91, v91
    v_exp_f32 v92, v92
    buffer_load_dwordx4 v[200:203], v1, s[24:27], s13 offen sc1
    s_add_u32 s13, s13, s15
    v_exp_f32 v93, v93
    v_exp_f32 v94, v94
    s_waitcnt lgkmcnt(3)
    v_mfma_f32_32x32x16_bf16 v[72:87], v[16:19], v[12:15], v[56:71]
    ds_read_b128 v[16:19], v1 offset:57344
    v_exp_f32 v95, v95
    v_cvt_pk_bf16_f32 v88, v88, v89
    v_cvt_pk_bf16_f32 v89, v90, v91
    v_cvt_pk_bf16_f32 v90, v92, v93
    v_cvt_pk_bf16_f32 v91, v94, v95
    v_exp_f32 v96, v96
    v_exp_f32 v97, v97
    v_mfma_f32_32x32x16_bf16 v[40:55], v[32:35], v[88:91], v[40:55]
    v_exp_f32 v98, v98
    v_exp_f32 v99, v99
    v_exp_f32 v100, v100
    v_exp_f32 v101, v101
    v_exp_f32 v102, v102
    v_exp_f32 v103, v103
    v_cvt_pk_bf16_f32 v96, v96, v97
    v_cvt_pk_bf16_f32 v97, v98, v99
    v_cvt_pk_bf16_f32 v98, v100, v101
    v_cvt_pk_bf16_f32 v99, v102, v103
    s_setprio 2
    v_exp_f32 v72, v72
    v_exp_f32 v73, v73
    v_mfma_f32_32x32x16_bf16 v[40:55], v[36:39], v[96:99], v[40:55]
    s_mov_b64 exec, s[54:55]
    ds_read_b128 v[32:35], v3 offset:56320
    ds_read_b128 v[36:39], v3 offset:56832
    s_mov_b64 exec, -1
    v_exp_f32 v74, v74
    v_exp_f32 v75, v75
    v_exp_f32 v76, v76
    buffer_load_dwordx4 v[204:207], v1, s[24:27], s14 offen sc1
    s_add_u32 s14, s14, s15
    buffer_load_dwordx4 v[208:211], v1, s[24:27], s13 offen sc1
    s_add_u32 s13, s13, s15
    s_add_u32 m0, s19, 66560
    s_add_u32 s49, s20, 33792
    buffer_load_dwordx4 v1, s[24:27], s49 offen sc1 lds
    v_exp_f32 v77, v77
    v_exp_f32 v78, v78
    s_waitcnt lgkmcnt(3)
    v_mfma_f32_32x32x16_bf16 v[88:103], v[20:23], v[12:15], v[56:71]
    ds_read_b128 v[20:23], v1 offset:58368
    v_exp_f32 v79, v79
    v_cvt_pk_bf16_f32 v72, v72, v73
    v_cvt_pk_bf16_f32 v73, v74, v75
    v_cvt_pk_bf16_f32 v74, v76, v77
    v_cvt_pk_bf16_f32 v75, v78, v79
    v_exp_f32 v80, v80
    v_exp_f32 v81, v81
    v_mfma_f32_32x32x16_bf16 v[40:55], v[24:27], v[72:75], v[40:55]
    v_exp_f32 v82, v82
    v_exp_f32 v83, v83
    v_exp_f32 v84, v84
    v_exp_f32 v85, v85
    v_exp_f32 v86, v86
    v_exp_f32 v87, v87
    v_cvt_pk_bf16_f32 v80, v80, v81
    v_cvt_pk_bf16_f32 v81, v82, v83
    v_cvt_pk_bf16_f32 v82, v84, v85
    v_cvt_pk_bf16_f32 v83, v86, v87
    v_exp_f32 v88, v88
    v_exp_f32 v89, v89
    v_mfma_f32_32x32x16_bf16 v[40:55], v[28:31], v[80:83], v[40:55]
    s_mov_b64 exec, s[54:55]
    ds_read_b128 v[24:27], v3 offset:57344
    ds_read_b128 v[28:31], v3 offset:57856
    s_mov_b64 exec, -1
    v_exp_f32 v90, v90
    v_exp_f32 v91, v91
    v_exp_f32 v92, v92
    buffer_load_dwordx4 v[212:215], v1, s[24:27], s14 offen sc1
    s_add_u32 s14, s14, s15
    v_exp_f32 v93, v93
    v_exp_f32 v94, v94
    s_waitcnt lgkmcnt(3)
    v_mfma_f32_32x32x16_bf16 v[72:87], v[16:19], v[12:15], v[56:71]
    ds_read_b128 v[16:19], v1 offset:59392
    v_exp_f32 v95, v95
    v_cvt_pk_bf16_f32 v88, v88, v89
    v_cvt_pk_bf16_f32 v89, v90, v91
    v_cvt_pk_bf16_f32 v90, v92, v93
    v_cvt_pk_bf16_f32 v91, v94, v95
    v_exp_f32 v96, v96
    v_exp_f32 v97, v97
    v_mfma_f32_32x32x16_bf16 v[40:55], v[32:35], v[88:91], v[40:55]
    v_exp_f32 v98, v98
    v_exp_f32 v99, v99
    v_exp_f32 v100, v100
    v_exp_f32 v101, v101
    v_exp_f32 v102, v102
    v_exp_f32 v103, v103
    v_cvt_pk_bf16_f32 v96, v96, v97
    v_cvt_pk_bf16_f32 v97, v98, v99
    v_cvt_pk_bf16_f32 v98, v100, v101
    v_cvt_pk_bf16_f32 v99, v102, v103
    v_exp_f32 v72, v72
    v_exp_f32 v73, v73
    v_mfma_f32_32x32x16_bf16 v[40:55], v[36:39], v[96:99], v[40:55]
    s_mov_b64 exec, s[54:55]
    ds_read_b128 v[32:35], v3 offset:58368
    ds_read_b128 v[36:39], v3 offset:58880
    s_mov_b64 exec, -1
    v_exp_f32 v74, v74
    v_exp_f32 v75, v75
    v_exp_f32 v76, v76
    buffer_load_dwordx4 v[216:219], v1, s[24:27], s13 offen sc1
    s_add_u32 s13, s13, s15
    buffer_load_dwordx4 v[220:223], v1, s[24:27], s14 offen sc1
    s_add_u32 s14, s14, s15
    v_exp_f32 v77, v77
    v_exp_f32 v78, v78
    s_waitcnt lgkmcnt(3)
    v_mfma_f32_32x32x16_bf16 v[88:103], v[20:23], v[12:15], v[56:71]
    ds_read_b128 v[20:23], v1 offset:60416
    v_exp_f32 v79, v79
    v_cvt_pk_bf16_f32 v72, v72, v73
    v_cvt_pk_bf16_f32 v73, v74, v75
    v_cvt_pk_bf16_f32 v74, v76, v77
    v_cvt_pk_bf16_f32 v75, v78, v79
    v_exp_f32 v80, v80
    v_exp_f32 v81, v81
    v_mfma_f32_32x32x16_bf16 v[40:55], v[24:27], v[72:75], v[40:55]
    v_exp_f32 v82, v82
    v_exp_f32 v83, v83
    v_exp_f32 v84, v84
    v_exp_f32 v85, v85
    v_exp_f32 v86, v86
    v_exp_f32 v87, v87
    v_cvt_pk_bf16_f32 v80, v80, v81
    v_cvt_pk_bf16_f32 v81, v82, v83
    v_cvt_pk_bf16_f32 v82, v84, v85
    v_cvt_pk_bf16_f32 v83, v86, v87
    v_exp_f32 v88, v88
    v_exp_f32 v89, v89
    v_mfma_f32_32x32x16_bf16 v[40:55], v[28:31], v[80:83], v[40:55]
    s_mov_b64 exec, s[54:55]
    ds_read_b128 v[24:27], v3 offset:59392
    ds_read_b128 v[28:31], v3 offset:59904
    s_mov_b64 exec, -1
    v_exp_f32 v90, v90
    v_exp_f32 v91, v91
    v_exp_f32 v92, v92
    buffer_load_dwordx4 v[224:227], v1, s[24:27], s13 offen sc1
    s_add_u32 s13, s13, s15
    s_add_u32 m0, s19, 67584
    s_add_u32 s49, s20, 34816
    buffer_load_dwordx4 v1, s[24:27], s49 offen sc1 lds
    v_exp_f32 v93, v93
    v_exp_f32 v94, v94
    s_waitcnt lgkmcnt(3)
    v_mfma_f32_32x32x16_bf16 v[72:87], v[16:19], v[12:15], v[56:71]
    ds_read_b128 v[16:19], v1 offset:61440
    v_exp_f32 v95, v95
    v_cvt_pk_bf16_f32 v88, v88, v89
    v_cvt_pk_bf16_f32 v89, v90, v91
    v_cvt_pk_bf16_f32 v90, v92, v93
    v_cvt_pk_bf16_f32 v91, v94, v95
    v_exp_f32 v96, v96
    v_exp_f32 v97, v97
    v_mfma_f32_32x32x16_bf16 v[40:55], v[32:35], v[88:91], v[40:55]
    v_exp_f32 v98, v98
    v_exp_f32 v99, v99
    v_exp_f32 v100, v100
    v_exp_f32 v101, v101
    v_exp_f32 v102, v102
    v_exp_f32 v103, v103
    v_cvt_pk_bf16_f32 v96, v96, v97
    v_cvt_pk_bf16_f32 v97, v98, v99
    v_cvt_pk_bf16_f32 v98, v100, v101
    v_cvt_pk_bf16_f32 v99, v102, v103
    v_exp_f32 v72, v72
    v_exp_f32 v73, v73
    v_mfma_f32_32x32x16_bf16 v[40:55], v[36:39], v[96:99], v[40:55]
    s_mov_b64 exec, s[54:55]
    ds_read_b128 v[32:35], v3 offset:60416
    ds_read_b128 v[36:39], v3 offset:60928
    s_mov_b64 exec, -1
    v_exp_f32 v74, v74
    v_exp_f32 v75, v75
    v_exp_f32 v76, v76
    buffer_load_dwordx4 v[228:231], v1, s[24:27], s14 offen sc1
    s_add_u32 s14, s14, s15
    buffer_load_dwordx4 v[232:235], v1, s[24:27], s13 offen sc1
    s_add_u32 s13, s13, s15
    v_exp_f32 v77, v77
    v_exp_f32 v78, v78
    s_waitcnt lgkmcnt(3)
    v_mfma_f32_32x32x16_bf16 v[88:103], v[20:23], v[12:15], v[56:71]
    ds_read_b128 v[20:23], v1 offset:62464
    v_exp_f32 v79, v79
    v_cvt_pk_bf16_f32 v72, v72, v73
    v_cvt_pk_bf16_f32 v73, v74, v75
    v_cvt_pk_bf16_f32 v74, v76, v77
    v_cvt_pk_bf16_f32 v75, v78, v79
    v_exp_f32 v80, v80
    v_exp_f32 v81, v81
    v_mfma_f32_32x32x16_bf16 v[40:55], v[24:27], v[72:75], v[40:55]
    v_exp_f32 v82, v82
    v_exp_f32 v83, v83
    v_exp_f32 v84, v84
    v_exp_f32 v85, v85
    v_exp_f32 v86, v86
    v_exp_f32 v87, v87
    v_cvt_pk_bf16_f32 v80, v80, v81
    v_cvt_pk_bf16_f32 v81, v82, v83
    v_cvt_pk_bf16_f32 v82, v84, v85
    v_cvt_pk_bf16_f32 v83, v86, v87
    v_exp_f32 v88, v88
    v_exp_f32 v89, v89
    v_mfma_f32_32x32x16_bf16 v[40:55], v[28:31], v[80:83], v[40:55]
    s_mov_b64 exec, s[54:55]
    ds_read_b128 v[24:27], v3 offset:61440
    ds_read_b128 v[28:31], v3 offset:61952
    s_mov_b64 exec, -1
    v_exp_f32 v90, v90
    v_exp_f32 v91, v91
    v_exp_f32 v92, v92
    buffer_load_dwordx4 v[236:239], v1, s[24:27], s14 offen sc1
    s_add_u32 s14, s14, s15
    s_add_u32 m0, s19, 68608
    s_add_u32 s49, s20, 35840
    buffer_load_dwordx4 v1, s[24:27], s49 offen sc1 lds
    v_exp_f32 v93, v93
    v_exp_f32 v94, v94
    s_waitcnt lgkmcnt(3)
    v_mfma_f32_32x32x16_bf16 v[72:87], v[16:19], v[12:15], v[56:71]
    ds_read_b128 v[16:19], v1 offset:63488
    v_exp_f32 v95, v95
    v_cvt_pk_bf16_f32 v88, v88, v89
    v_cvt_pk_bf16_f32 v89, v90, v91
    v_cvt_pk_bf16_f32 v90, v92, v93
    v_cvt_pk_bf16_f32 v91, v94, v95
    v_exp_f32 v96, v96
    v_exp_f32 v97, v97
    v_mfma_f32_32x32x16_bf16 v[40:55], v[32:35], v[88:91], v[40:55]
    v_exp_f32 v98, v98
    v_exp_f32 v99, v99
    v_exp_f32 v100, v100
    v_exp_f32 v101, v101
    v_exp_f32 v102, v102
    v_exp_f32 v103, v103
    v_cvt_pk_bf16_f32 v96, v96, v97
    v_cvt_pk_bf16_f32 v97, v98, v99
    v_cvt_pk_bf16_f32 v98, v100, v101
    v_cvt_pk_bf16_f32 v99, v102, v103
    s_setprio 1
    v_exp_f32 v72, v72
    v_exp_f32 v73, v73
    v_mfma_f32_32x32x16_bf16 v[40:55], v[36:39], v[96:99], v[40:55]
    s_mov_b64 exec, s[54:55]
    ds_read_b128 v[32:35], v3 offset:62464
    ds_read_b128 v[36:39], v3 offset:62976
    s_mov_b64 exec, -1
    v_exp_f32 v74, v74
    v_exp_f32 v75, v75
    v_exp_f32 v76, v76
    buffer_load_dwordx4 v[240:243], v1, s[24:27], s13 offen sc1
    s_add_u32 s13, s13, s15
    buffer_load_dwordx4 v[244:247], v1, s[24:27], s14 offen sc1
    s_add_u32 s14, s14, s15
    v_exp_f32 v77, v77
    v_exp_f32 v78, v78
    s_waitcnt lgkmcnt(3)
    v_mfma_f32_32x32x16_bf16 v[88:103], v[20:23], v[12:15], v[56:71]
    ds_read_b128 v[20:23], v1 offset:64512
    v_exp_f32 v79, v79
    v_cvt_pk_bf16_f32 v72, v72, v73
    v_cvt_pk_bf16_f32 v73, v74, v75
    v_cvt_pk_bf16_f32 v74, v76, v77
    v_cvt_pk_bf16_f32 v75, v78, v79
    v_exp_f32 v80, v80
    v_exp_f32 v81, v81
    v_mfma_f32_32x32x16_bf16 v[40:55], v[24:27], v[72:75], v[40:55]
    v_exp_f32 v82, v82
    v_exp_f32 v83, v83
    v_exp_f32 v84, v84
    v_exp_f32 v85, v85
    v_exp_f32 v86, v86
    v_exp_f32 v87, v87
    v_cvt_pk_bf16_f32 v80, v80, v81
    v_cvt_pk_bf16_f32 v81, v82, v83
    v_cvt_pk_bf16_f32 v82, v84, v85
    v_cvt_pk_bf16_f32 v83, v86, v87
    v_exp_f32 v88, v88
    v_exp_f32 v89, v89
    v_mfma_f32_32x32x16_bf16 v[40:55], v[28:31], v[80:83], v[40:55]
    s_mov_b64 exec, s[54:55]
    ds_read_b128 v[24:27], v3 offset:63488
    ds_read_b128 v[28:31], v3 offset:64000
    s_mov_b64 exec, -1
    v_exp_f32 v90, v90
    v_exp_f32 v91, v91
    v_exp_f32 v92, v92
    buffer_load_dwordx4 v[248:251], v1, s[24:27], s13 offen sc1
    s_add_u32 s13, s13, s15
    buffer_load_dwordx2 v[8:9], v7, s[28:31], s17 offen
    v_exp_f32 v93, v93
    v_exp_f32 v94, v94
    s_waitcnt lgkmcnt(3)
    v_mfma_f32_32x32x16_bf16 v[72:87], v[16:19], v[12:15], v[56:71]
    v_exp_f32 v95, v95
    v_cvt_pk_bf16_f32 v88, v88, v89
    v_cvt_pk_bf16_f32 v89, v90, v91
    v_cvt_pk_bf16_f32 v90, v92, v93
    v_cvt_pk_bf16_f32 v91, v94, v95
    v_exp_f32 v96, v96
    v_exp_f32 v97, v97
    v_mfma_f32_32x32x16_bf16 v[40:55], v[32:35], v[88:91], v[40:55]
    v_exp_f32 v98, v98
    v_exp_f32 v99, v99
    v_exp_f32 v100, v100
    v_exp_f32 v101, v101
    v_exp_f32 v102, v102
    v_exp_f32 v103, v103
    v_cvt_pk_bf16_f32 v96, v96, v97
    v_cvt_pk_bf16_f32 v97, v98, v99
    v_cvt_pk_bf16_f32 v98, v100, v101
    v_cvt_pk_bf16_f32 v99, v102, v103
    v_exp_f32 v72, v72
    v_exp_f32 v73, v73
    v_mfma_f32_32x32x16_bf16 v[40:55], v[36:39], v[96:99], v[40:55]
    s_mov_b64 exec, s[54:55]
    ds_read_b128 v[32:35], v3 offset:64512
    ds_read_b128 v[36:39], v3 offset:65024
    s_mov_b64 exec, -1
    v_exp_f32 v74, v74
    v_exp_f32 v75, v75
    v_exp_f32 v76, v76
    buffer_load_dwordx4 v[252:255], v1, s[24:27], s14 offen sc1
    s_add_u32 s14, s14, s15
    buffer_load_dwordx2 v[10:11], v7, s[28:31], s17 offen offset:16
    v_exp_f32 v77, v77
    v_exp_f32 v78, v78
    s_waitcnt lgkmcnt(2)
    v_mfma_f32_32x32x16_bf16 v[88:103], v[20:23], v[12:15], v[56:71]
    v_exp_f32 v79, v79
    v_cvt_pk_bf16_f32 v72, v72, v73
    v_cvt_pk_bf16_f32 v73, v74, v75
    v_cvt_pk_bf16_f32 v74, v76, v77
    v_cvt_pk_bf16_f32 v75, v78, v79
    v_exp_f32 v80, v80
    v_exp_f32 v81, v81
    v_mfma_f32_32x32x16_bf16 v[40:55], v[24:27], v[72:75], v[40:55]
    v_exp_f32 v82, v82
    v_exp_f32 v83, v83
    v_exp_f32 v84, v84
    v_exp_f32 v85, v85
    v_exp_f32 v86, v86
    v_exp_f32 v87, v87
    v_cvt_pk_bf16_f32 v80, v80, v81
    v_cvt_pk_bf16_f32 v81, v82, v83
    v_cvt_pk_bf16_f32 v82, v84, v85
    v_cvt_pk_bf16_f32 v83, v86, v87
    s_setprio 0
    v_exp_f32 v88, v88
    v_exp_f32 v89, v89
    v_mfma_f32_32x32x16_bf16 v[40:55], v[28:31], v[80:83], v[40:55]
    v_exp_f32 v90, v90
    v_exp_f32 v91, v91
    v_exp_f32 v92, v92
    v_exp_f32 v93, v93
    v_exp_f32 v94, v94
    v_exp_f32 v95, v95
    v_cvt_pk_bf16_f32 v88, v88, v89
    v_cvt_pk_bf16_f32 v89, v90, v91
    v_cvt_pk_bf16_f32 v90, v92, v93
    v_cvt_pk_bf16_f32 v91, v94, v95
    v_exp_f32 v96, v96
    v_exp_f32 v97, v97
    s_waitcnt lgkmcnt(0)
    v_mfma_f32_32x32x16_bf16 v[40:55], v[32:35], v[88:91], v[40:55]
    v_exp_f32 v98, v98
    v_exp_f32 v99, v99
    v_exp_f32 v100, v100
    v_exp_f32 v101, v101
    v_exp_f32 v102, v102
    v_exp_f32 v103, v103
    v_cvt_pk_bf16_f32 v96, v96, v97
    v_cvt_pk_bf16_f32 v97, v98, v99
    v_cvt_pk_bf16_f32 v98, v100, v101
    v_cvt_pk_bf16_f32 v99, v102, v103
    s_nop 1
    v_mfma_f32_32x32x16_bf16 v[40:55], v[36:39], v[96:99], v[40:55]
    s_setprio 0
    s_nop 11
    v_mov_b32 v49, v48
    s_nop 1
    v_permlane32_swap_b32 v48, v49
    v_max3_f32 v2, |v40|, |v41|, |v42|
    v_max3_f32 v2, v2, |v43|, |v44|
    v_max3_f32 v2, v2, |v45|, |v46|
    v_max3_f32 v2, v2, |v47|, |v48|
    v_add_f32 v6, v40, v41
    v_add_f32 v6, v6, v42
    v_add_f32 v6, v6, v43
    v_add_f32 v6, v6, v44
    v_add_f32 v6, v6, v45
    v_add_f32 v6, v6, v46
    v_add_f32 v6, v6, v47
    v_add_f32 v6, v6, v48
    v_mov_b32 v104, 0x71800000
    v_cmp_nlt_f32 vcc, v2, v104
    v_cmp_u_f32 s[56:57], v6, v6
    s_or_b64 vcc, vcc, s[56:57]
    s_cmp_eq_u64 vcc, 0
    s_cbranch_scc1 L_fin
    v_mov_b32 v2, 0xff800000
    s_lshl_b32 s48, s6, 16
    s_add_u32 s48, s48, 0x200000
    s_mov_b32 s51, 64
L_mx:
    buffer_load_dwordx4 v[16:19], v1, s[24:27], s48 offen sc1
    s_add_u32 s48, s48, 1024
    s_waitcnt vmcnt(0)
    v_mfma_f32_32x32x16_bf16 v[72:87], v[16:19], v[12:15], 0
    s_nop 11
    v_max3_f32 v104, v72, v73, v74
    v_max3_f32 v104, v104, v75, v76
    v_max3_f32 v104, v104, v77, v78
    v_max3_f32 v104, v104, v79, v80
    v_max3_f32 v104, v104, v81, v82
    v_max3_f32 v104, v104, v83, v84
    v_max3_f32 v104, v104, v85, v86
    v_max_f32 v104, v104, v87
    v_max_f32 v2, v2, v104
    s_sub_u32 s51, s51, 1
    s_cmp_lg_u32 s51, 0
    s_cbranch_scc1 L_mx
    v_mov_b32 v6, v2
    s_nop 1
    v_permlane32_swap_b32 v6, v2
    v_max_f32 v6, v6, v2
    v_sub_f32 v56, 0, v6
    v_sub_f32 v57, 0, v6
    v_sub_f32 v58, 0, v6
    v_sub_f32 v59, 0, v6
    v_sub_f32 v60, 0, v6
    v_sub_f32 v61, 0, v6
    v_sub_f32 v62, 0, v6
    v_sub_f32 v63, 0, v6
    v_sub_f32 v64, 0, v6
    v_sub_f32 v65, 0, v6
    v_sub_f32 v66, 0, v6
    v_sub_f32 v67, 0, v6
    v_sub_f32 v68, 0, v6
    v_sub_f32 v69, 0, v6
    v_sub_f32 v70, 0, v6
    v_sub_f32 v71, 0, v6
    s_nop 1
    v_mov_b32 v40, 0
    v_mov_b32 v41, 0
    v_mov_b32 v42, 0
    v_mov_b32 v43, 0
    v_mov_b32 v44, 0
    v_mov_b32 v45, 0
    v_mov_b32 v46, 0
    v_mov_b32 v47, 0
    v_mov_b32 v48, 0
    v_mov_b32 v49, 0
    v_mov_b32 v50, 0
    v_mov_b32 v51, 0
    v_mov_b32 v52, 0
    v_mov_b32 v53, 0
    v_mov_b32 v54, 0
    v_mov_b32 v55, 0
    v_subrev_u32 v105, 65536, v3
    s_lshl_b32 s48, s6, 16
    s_add_u32 s49, s48, 0x400000
    s_add_u32 s48, s48, 0x200000
    s_mov_b32 s51, 64
L_rc:
    buffer_load_dwordx4 v[16:19], v1, s[24:27], s48 offen sc1
    s_mov_b64 exec, s[54:55]
    buffer_load_dwordx4 v[24:27], v105, s[24:27], s49 offen sc1
    buffer_load_dwordx4 v[28:31], v105, s[24:27], s49 offen offset:512 sc1
    s_mov_b64 exec, -1
    s_add_u32 s48, s48, 1024
    s_add_u32 s49, s49, 1024
    s_waitcnt vmcnt(0)
    v_mfma_f32_32x32x16_bf16 v[72:87], v[16:19], v[12:15], v[56:71]
    s_nop 11
    v_exp_f32 v72, v72
    v_exp_f32 v73, v73
    v_exp_f32 v74, v74
    v_exp_f32 v75, v75
    v_exp_f32 v76, v76
    v_exp_f32 v77, v77
    v_exp_f32 v78, v78
    v_exp_f32 v79, v79
    v_exp_f32 v80, v80
    v_exp_f32 v81, v81
    v_exp_f32 v82, v82
    v_exp_f32 v83, v83
    v_exp_f32 v84, v84
    v_exp_f32 v85, v85
    v_exp_f32 v86, v86
    v_exp_f32 v87, v87
    s_nop 0
    v_cvt_pk_bf16_f32 v72, v72, v73
    v_cvt_pk_bf16_f32 v73, v74, v75
    v_cvt_pk_bf16_f32 v74, v76, v77
    v_cvt_pk_bf16_f32 v75, v78, v79
    v_cvt_pk_bf16_f32 v80, v80, v81
    v_cvt_pk_bf16_f32 v81, v82, v83
    v_cvt_pk_bf16_f32 v82, v84, v85
    v_cvt_pk_bf16_f32 v83, v86, v87
    s_nop 1
    v_mfma_f32_32x32x16_bf16 v[40:55], v[24:27], v[72:75], v[40:55]
    v_mfma_f32_32x32x16_bf16 v[40:55], v[28:31], v[80:83], v[40:55]
    s_sub_u32 s51, s51, 1
    s_cmp_lg_u32 s51, 0
    s_cbranch_scc1 L_rc
    s_nop 11
    v_mov_b32 v49, v48
    s_nop 1
    v_permlane32_swap_b32 v48, v49
L_fin:
    v_rcp_f32 v2, v48
    s_nop 0
    v_mul_f32 v40, v40, v2
    v_mul_f32 v41, v41, v2
    v_mul_f32 v42, v42, v2
    v_mul_f32 v43, v43, v2
    v_mul_f32 v44, v44, v2
    v_mul_f32 v45, v45, v2
    v_mul_f32 v46, v46, v2
    v_mul_f32 v47, v47, v2
    v_cvt_pk_bf16_f32 v40, v40, v41
    v_cvt_pk_bf16_f32 v41, v42, v43
    v_cvt_pk_bf16_f32 v42, v44, v45
    v_cvt_pk_bf16_f32 v43, v46, v47
    buffer_store_dwordx4 v[40:43], v1, s[24:27], s65 offen sc1
    v_lshrrev_b32 v6, 8, v1
    v_lshlrev_b32 v6, 12, v6
    v_bfe_u32 v7, v1, 4, 4
    v_lshl_add_u32 v6, v7, 3, v6
    s_lshl_b32 s18, s7, 14
    s_lshl_b32 s48, s6, 7
    s_add_u32 s18, s18, s48
    s_add_u32 s18, s18, 0x17c0000
    s_waitcnt vmcnt(0)
    s_barrier
    s_cmp_lg_u32 s22, 0
    s_cbranch_scc1 L_w0_sequen_22
    s_mov_b64 exec, -1
    buffer_store_dwordx2 v[4:5], v6, s[24:27], s18 offen sc1
    s_mov_b64 exec, -1
L_w0_sequen_22:
    v_lshrrev_b32 v6, 4, v1
    v_lshrrev_b32 v7, 4, v6
    v_lshrrev_b32 v12, 2, v6
    v_xor_b32 v7, v7, v12
    v_and_b32 v7, 1, v7
    v_subrev_u32 v7, 1, v7
    v_and_b32 v120, 0x3f803f80, v7
    v_mov_b32 v121, v120
    v_mov_b32 v122, v120
    v_mov_b32 v123, v120
    s_nop 1
    v_mfma_f32_16x16x32_bf16 v[124:127], v[120:123], v[128:131], 0
    v_mfma_f32_16x16x32_bf16 v[124:127], v[120:123], v[132:135], v[124:127]
    v_mfma_f32_16x16x32_bf16 v[124:127], v[120:123], v[136:139], v[124:127]
    v_mfma_f32_16x16x32_bf16 v[124:127], v[120:123], v[140:143], v[124:127]
    v_mfma_f32_16x16x32_bf16 v[124:127], v[120:123], v[144:147], v[124:127]
    v_mfma_f32_16x16x32_bf16 v[124:127], v[120:123], v[148:151], v[124:127]
    v_mfma_f32_16x16x32_bf16 v[124:127], v[120:123], v[152:155], v[124:127]
    v_mfma_f32_16x16x32_bf16 v[124:127], v[120:123], v[156:159], v[124:127]
    v_mfma_f32_16x16x32_bf16 v[124:127], v[120:123], v[160:163], v[124:127]
    v_mfma_f32_16x16x32_bf16 v[124:127], v[120:123], v[164:167], v[124:127]
    v_mfma_f32_16x16x32_bf16 v[124:127], v[120:123], v[168:171], v[124:127]
    v_mfma_f32_16x16x32_bf16 v[124:127], v[120:123], v[172:175], v[124:127]
    v_mfma_f32_16x16x32_bf16 v[124:127], v[120:123], v[176:179], v[124:127]
    v_mfma_f32_16x16x32_bf16 v[124:127], v[120:123], v[180:183], v[124:127]
    v_mfma_f32_16x16x32_bf16 v[124:127], v[120:123], v[184:187], v[124:127]
    v_mfma_f32_16x16x32_bf16 v[124:127], v[120:123], v[188:191], v[124:127]
    v_mfma_f32_16x16x32_bf16 v[124:127], v[120:123], v[192:195], v[124:127]
    v_mfma_f32_16x16x32_bf16 v[124:127], v[120:123], v[196:199], v[124:127]
    v_mfma_f32_16x16x32_bf16 v[124:127], v[120:123], v[200:203], v[124:127]
    v_mfma_f32_16x16x32_bf16 v[124:127], v[120:123], v[204:207], v[124:127]
    v_mfma_f32_16x16x32_bf16 v[124:127], v[120:123], v[208:211], v[124:127]
    v_mfma_f32_16x16x32_bf16 v[124:127], v[120:123], v[212:215], v[124:127]
    v_mfma_f32_16x16x32_bf16 v[124:127], v[120:123], v[216:219], v[124:127]
    v_mfma_f32_16x16x32_bf16 v[124:127], v[120:123], v[220:223], v[124:127]
    v_mfma_f32_16x16x32_bf16 v[124:127], v[120:123], v[224:227], v[124:127]
    v_mfma_f32_16x16x32_bf16 v[124:127], v[120:123], v[228:231], v[124:127]
    v_mfma_f32_16x16x32_bf16 v[124:127], v[120:123], v[232:235], v[124:127]
    v_mfma_f32_16x16x32_bf16 v[124:127], v[120:123], v[236:239], v[124:127]
    v_mfma_f32_16x16x32_bf16 v[124:127], v[120:123], v[240:243], v[124:127]
    v_mfma_f32_16x16x32_bf16 v[124:127], v[120:123], v[244:247], v[124:127]
    v_mfma_f32_16x16x32_bf16 v[124:127], v[120:123], v[248:251], v[124:127]
    v_mfma_f32_16x16x32_bf16 v[124:127], v[120:123], v[252:255], v[124:127]
    v_and_b32 v7, 31, v6
    v_lshlrev_b32 v7, 2, v7
    s_lshl_b32 s48, s22, 7
    s_add_u32 s48, s48, 147456
    v_add_u32 v7, s48, v7
    s_nop 4
    ds_write_b32 v7, v124
    s_lshl_b32 s50, s10, 13
    v_add_u32 v7, s50, v1
    s_lshl_b32 s50, s8, 16
    v_add_u32 v52, s50, v7
    s_lshl_b32 s50, s9, 16
    v_add_u32 v7, s50, v7
    ds_read_b128 v[56:59], v52 offset:0
    ds_read_b128 v[60:63], v52 offset:1024
    ds_read_b128 v[64:67], v52 offset:2048
    ds_read_b128 v[68:71], v52 offset:3072
    ds_read_b128 v[72:75], v52 offset:4096
    ds_read_b128 v[76:79], v52 offset:5120
    ds_read_b128 v[80:83], v52 offset:6144
    ds_read_b128 v[84:87], v52 offset:7168
    ds_read_b128 v[88:91], v52 offset:16384
    ds_read_b128 v[92:95], v52 offset:17408
    ds_read_b128 v[96:99], v52 offset:18432
    ds_read_b128 v[100:103], v52 offset:19456
    ds_read_b128 v[104:107], v52 offset:20480
    ds_read_b128 v[108:111], v52 offset:21504
    ds_read_b128 v[112:115], v52 offset:22528
    ds_read_b128 v[116:119], v52 offset:23552
    s_cmp_eq_u32 s10, 0
    s_cselect_b64 vcc, -1, 0
    v_lshlrev_b32 v12, 16, v8
    v_and_b32 v13, 0xffff0000, v8
    v_lshlrev_b32 v14, 16, v9
    v_and_b32 v15, 0xffff0000, v9
    v_lshlrev_b32 v16, 16, v10
    v_and_b32 v17, 0xffff0000, v10
    v_lshlrev_b32 v18, 16, v11
    v_and_b32 v19, 0xffff0000, v11
    v_cndmask_b32 v24, 0, v12, vcc
    v_cndmask_b32 v32, v12, 0, vcc
    v_cndmask_b32 v25, 0, v13, vcc
    v_cndmask_b32 v33, v13, 0, vcc
    v_cndmask_b32 v26, 0, v14, vcc
    v_cndmask_b32 v34, v14, 0, vcc
    v_cndmask_b32 v27, 0, v15, vcc
    v_cndmask_b32 v35, v15, 0, vcc
    v_cndmask_b32 v28, 0, v16, vcc
    v_cndmask_b32 v36, v16, 0, vcc
    v_cndmask_b32 v29, 0, v17, vcc
    v_cndmask_b32 v37, v17, 0, vcc
    v_cndmask_b32 v30, 0, v18, vcc
    v_cndmask_b32 v38, v18, 0, vcc
    v_cndmask_b32 v31, 0, v19, vcc
    v_cndmask_b32 v39, v19, 0, vcc
    s_lshl_b32 s48, s22, 11
    s_add_u32 s48, s48, 131072
    v_add_u32 v52, s48, v1
    v_xor_b32 v53, 2048, v52
    s_waitcnt lgkmcnt(0)
    s_cmp_lg_u32 s22, 0
    s_cbranch_scc1 L_w0_sequen_23
    v_lshlrev_b32 v6, 3, v1
    s_lshl_b32 s48, s5, 12
    s_add_u32 s48, s48, 0x17c0000
    s_mov_b32 s51, 0
    s_mov_b32 exec_hi, 0
    s_mov_b32 exec_lo, 0xffffffff
L_poll_sequen_24:
    buffer_load_dwordx2 v[2:3], v6, s[24:27], s48 offen sc1
    s_add_u32 s51, s51, 1
    s_waitcnt vmcnt(0)
    v_cmp_eq_u64 vcc, v[2:3], v[4:5]
    s_cmp_gt_u32 s51, 400000
    s_cbranch_scc1 L_pdone_sequen_25
    s_cmp_eq_u64 vcc, exec
    s_cbranch_scc0 L_poll_sequen_24
L_pdone_sequen_25:
    s_mov_b64 exec, -1
L_w0_sequen_23:
    s_barrier
    s_lshl_b32 s48, s5, 16
    s_add_u32 s48, s48, s19
    s_add_u32 m0, s19, 32768
    s_add_u32 s50, s48, 0xb00000
    buffer_load_dwordx4 v1, s[24:27], s50 offen offset:0 sc1 lds
    buffer_load_dwordx4 v1, s[24:27], s50 offen offset:1024 sc1 lds
    buffer_load_dwordx4 v1, s[24:27], s50 offen offset:2048 sc1 lds
    buffer_load_dwordx4 v1, s[24:27], s50 offen offset:3072 sc1 lds
    s_add_u32 m0, s19, 98304
    s_add_u32 s50, s48, 0xb08000
    buffer_load_dwordx4 v1, s[24:27], s50 offen offset:0 sc1 lds
    buffer_load_dwordx4 v1, s[24:27], s50 offen offset:1024 sc1 lds
    buffer_load_dwordx4 v1, s[24:27], s50 offen offset:2048 sc1 lds
    buffer_load_dwordx4 v1, s[24:27], s50 offen offset:3072 sc1 lds
    s_cmp_ge_u32 s22, 4
    s_cbranch_scc1 L_fh_sequen_26
    s_waitcnt vmcnt(0)
L_fh_sequen_26:
    s_barrier
    ds_read_b128 v[12:15], v7 offset:32768
    ds_read_b128 v[16:19], v7 offset:33792
    ds_read_b128 v[20:23], v7 offset:34816
    ds_read_b128 v[40:43], v7 offset:35840
    ds_read_b128 v[44:47], v7 offset:36864
    s_waitcnt lgkmcnt(4)
    v_mfma_f32_32x32x16_bf16 v[24:39], v[56:59], v[12:15], v[24:39]
    ds_read_b128 v[48:51], v7 offset:37888
    s_waitcnt lgkmcnt(4)
    v_mfma_f32_32x32x16_bf16 v[24:39], v[60:63], v[16:19], v[24:39]
    ds_read_b128 v[12:15], v7 offset:38912
    s_waitcnt lgkmcnt(4)
    v_mfma_f32_32x32x16_bf16 v[24:39], v[64:67], v[20:23], v[24:39]
    ds_read_b128 v[16:19], v7 offset:39936
    s_waitcnt vmcnt(0)
    s_barrier
    s_waitcnt lgkmcnt(4)
    v_mfma_f32_32x32x16_bf16 v[24:39], v[68:71], v[40:43], v[24:39]
    ds_read_b128 v[20:23], v7 offset:49152
    s_waitcnt lgkmcnt(4)
    v_mfma_f32_32x32x16_bf16 v[24:39], v[72:75], v[44:47], v[24:39]
    ds_read_b128 v[40:43], v7 offset:50176
    s_waitcnt lgkmcnt(4)
    v_mfma_f32_32x32x16_bf16 v[24:39], v[76:79], v[48:51], v[24:39]
    ds_read_b128 v[44:47], v7 offset:51200
    s_waitcnt lgkmcnt(4)
    v_mfma_f32_32x32x16_bf16 v[24:39], v[80:83], v[12:15], v[24:39]
    ds_read_b128 v[48:51], v7 offset:52224
    s_waitcnt lgkmcnt(4)
    v_mfma_f32_32x32x16_bf16 v[24:39], v[84:87], v[16:19], v[24:39]
    ds_read_b128 v[12:15], v7 offset:53248
    s_waitcnt lgkmcnt(4)
    v_mfma_f32_32x32x16_bf16 v[24:39], v[88:91], v[20:23], v[24:39]
    ds_read_b128 v[16:19], v7 offset:54272
    s_waitcnt lgkmcnt(4)
    v_mfma_f32_32x32x16_bf16 v[24:39], v[92:95], v[40:43], v[24:39]
    ds_read_b128 v[20:23], v7 offset:55296
    s_waitcnt lgkmcnt(4)
    v_mfma_f32_32x32x16_bf16 v[24:39], v[96:99], v[44:47], v[24:39]
    ds_read_b128 v[40:43], v7 offset:56320
    s_waitcnt lgkmcnt(4)
    v_mfma_f32_32x32x16_bf16 v[24:39], v[100:103], v[48:51], v[24:39]
    s_waitcnt lgkmcnt(3)
    v_mfma_f32_32x32x16_bf16 v[24:39], v[104:107], v[12:15], v[24:39]
    s_waitcnt lgkmcnt(2)
    v_mfma_f32_32x32x16_bf16 v[24:39], v[108:111], v[16:19], v[24:39]
    s_waitcnt lgkmcnt(1)
    v_mfma_f32_32x32x16_bf16 v[24:39], v[112:115], v[20:23], v[24:39]
    s_waitcnt lgkmcnt(0)
    v_mfma_f32_32x32x16_bf16 v[24:39], v[116:119], v[40:43], v[24:39]
    s_cmp_lg_u32 s10, 0
    s_nop 9
    s_cbranch_scc1 L_ex_sequen_27
    ds_write_b128 v52, v[32:35]
    ds_write_b128 v52, v[36:39] offset:1024
    s_waitcnt lgkmcnt(0)
    s_barrier
    ds_read_b128 v[40:43], v53
    ds_read_b128 v[44:47], v53 offset:1024
    s_waitcnt lgkmcnt(0)
    v_add_f32 v48, v24, v40
    v_add_f32 v49, v25, v41
    v_add_f32 v50, v26, v42
    v_add_f32 v51, v27, v43
    v_add_f32 v52, v28, v44
    v_add_f32 v53, v29, v45
    v_add_f32 v54, v30, v46
    v_add_f32 v55, v31, v47
    s_branch L_exj_sequen_28
L_ex_sequen_27:
    ds_write_b128 v52, v[24:27]
    ds_write_b128 v52, v[28:31] offset:1024
    s_waitcnt lgkmcnt(0)
    s_barrier
    ds_read_b128 v[40:43], v53
    ds_read_b128 v[44:47], v53 offset:1024
    s_waitcnt lgkmcnt(0)
    v_add_f32 v48, v32, v40
    v_add_f32 v49, v33, v41
    v_add_f32 v50, v34, v42
    v_add_f32 v51, v35, v43
    v_add_f32 v52, v36, v44
    v_add_f32 v53, v37, v45
    v_add_f32 v54, v38, v46
    v_add_f32 v55, v39, v47
L_exj_sequen_28:
    v_cvt_pk_bf16_f32 v8, v48, v49
    v_cvt_pk_bf16_f32 v9, v50, v51
    v_cvt_pk_bf16_f32 v10, v52, v53
    v_cvt_pk_bf16_f32 v11, v54, v55
    s_cmp_lg_u32 s70, 0
    s_cbranch_scc1 L_stl_sequen_29
    buffer_store_dwordx4 v[8:11], v1, s[24:27], s61 offen sc1
    s_branch L_stj_sequen_30
L_stl_sequen_29:
    buffer_store_dwordx4 v[8:11], v1, s[24:27], s61 offen
L_stj_sequen_30:
    v_lshlrev_b32 v48, 16, v8
    v_and_b32 v49, 0xffff0000, v8
    v_lshlrev_b32 v50, 16, v9
    v_and_b32 v51, 0xffff0000, v9
    v_lshlrev_b32 v52, 16, v10
    v_and_b32 v53, 0xffff0000, v10
    v_lshlrev_b32 v54, 16, v11
    v_and_b32 v55, 0xffff0000, v11
    v_add_f32 v40, v48, v49
    v_mul_f32 v41, v48, v48
    v_fmac_f32 v41, v49, v49
    v_add_f32 v40, v40, v50
    v_fmac_f32 v41, v50, v50
    v_add_f32 v40, v40, v51
    v_fmac_f32 v41, v51, v51
    v_add_f32 v40, v40, v52
    v_fmac_f32 v41, v52, v52
    v_add_f32 v40, v40, v53
    v_fmac_f32 v41, v53, v53
    v_add_f32 v40, v40, v54
    v_fmac_f32 v41, v54, v54
    v_add_f32 v40, v40, v55
    v_fmac_f32 v41, v55, v55
    v_mov_b32 v42, v40
    v_mov_b32 v43, v41
    v_lshrrev_b32 v6, 1, v1
    s_nop 0
    v_permlane32_swap_b32 v40, v42
    v_permlane32_swap_b32 v41, v43
    v_add_f32 v40, v40, v42
    v_add_f32 v41, v41, v43
    s_mov_b32 exec_hi, 0
    s_cmp_lg_u32 s70, 0
    s_cbranch_scc1 L_stl_sequen_31
    buffer_store_dwordx2 v[40:41], v6, s[24:27], s62 offen sc1
    s_branch L_stj_sequen_32
L_stl_sequen_31:
    buffer_store_dwordx2 v[40:41], v6, s[24:27], s62 offen
L_stj_sequen_32:
    s_mov_b32 exec_hi, -1
    s_lshl_b32 s18, s5, 10
    s_lshl_b32 s48, s4, 7
    s_add_u32 s18, s18, s48
    s_add_u32 s18, s18, 0x17a8000
    s_waitcnt vmcnt(0)
    s_barrier
    s_cmp_lg_u32 s22, 0
    s_cbranch_scc1 L_w0_sequen_33
    s_mov_b64 exec, 0xffff
    s_cmp_lg_u32 s70, 0
    s_cbranch_scc1 L_stl_sequen_34
    buffer_store_dwordx2 v[4:5], v6, s[24:27], s18 offen sc1
    s_branch L_stj_sequen_35
L_stl_sequen_34:
    buffer_store_dwordx2 v[4:5], v6, s[24:27], s18 offen
L_stj_sequen_35:
    s_mov_b64 exec, -1
L_w0_sequen_33:
    s_cmp_lg_u32 s22, 0
    s_cbranch_scc1 L_w0_sequen_36
    v_lshlrev_b32 v6, 3, v1
    s_lshl_b32 s48, s5, 10
    s_add_u32 s48, s48, 0x17a8000
    s_mov_b32 s51, 0
    s_mov_b32 exec_hi, 0
    s_mov_b32 exec_lo, 0xff
L_poll_sequen_37:
    buffer_load_dwordx2 v[2:3], v6, s[24:27], s48 offen sc1
    s_add_u32 s51, s51, 1
    s_waitcnt vmcnt(0)
    v_cmp_eq_u64 vcc, v[2:3], v[4:5]
    s_cmp_gt_u32 s51, 400000
    s_cbranch_scc1 L_pdone_sequen_38
    s_cmp_eq_u64 vcc, exec
    s_cbranch_scc0 L_poll_sequen_37
L_pdone_sequen_38:
    s_mov_b64 exec, -1
L_w0_sequen_36:
    s_barrier
    s_lshl_b32 s48, s5, 16
    s_add_u32 s48, s48, s19
    s_add_u32 m0, s19, 0
    s_add_u32 s50, s48, 0xd00000
    buffer_load_dwordx4 v1, s[24:27], s50 offen offset:0 sc1 lds
    buffer_load_dwordx4 v1, s[24:27], s50 offen offset:1024 sc1 lds
    buffer_load_dwordx4 v1, s[24:27], s50 offen offset:2048 sc1 lds
    buffer_load_dwordx4 v1, s[24:27], s50 offen offset:3072 sc1 lds
    s_add_u32 m0, s19, 32768
    s_add_u32 s50, s48, 0xd08000
    buffer_load_dwordx4 v1, s[24:27], s50 offen offset:0 sc1 lds
    buffer_load_dwordx4 v1, s[24:27], s50 offen offset:1024 sc1 lds
    buffer_load_dwordx4 v1, s[24:27], s50 offen offset:2048 sc1 lds
    buffer_load_dwordx4 v1, s[24:27], s50 offen offset:3072 sc1 lds
    s_cmp_eq_u32 s22, 7
    s_cbranch_scc1 L_w7
    s_cmp_ge_u32 s22, 4
    s_cbranch_scc1 L_fh_sequen_39
    s_waitcnt vmcnt(0)
L_fh_sequen_39:
    s_barrier
    v_lshrrev_b32 v6, 4, v1
    v_and_b32 v6, 31, v6
    v_lshlrev_b32 v6, 2, v6
    v_add_u32 v6, 147456, v6
    s_lshl_b32 s48, s9, 7
    v_add_u32 v7, s48, v6
    v_lshrrev_b32 v2, 9, v1
    v_lshlrev_b32 v2, 4, v2
    s_lshl_b32 s48, s22, 7
    s_add_u32 s48, s48, 147456
    v_add_u32 v2, s48, v2
    ds_read_b128 v[56:59], v1 offset:0
    ds_read_b128 v[60:63], v1 offset:32768
    ds_read_b128 v[64:67], v1 offset:1024
    ds_read_b128 v[68:71], v1 offset:33792
    ds_read_b128 v[72:75], v1 offset:2048
    ds_read_b128 v[76:79], v1 offset:34816
    s_waitcnt lgkmcnt(5)
    v_mfma_f32_32x32x16_bf16 v[24:39], v[128:131], v[56:59], 0
    ds_read_b128 v[80:83], v1 offset:3072
    ds_read_b128 v[84:87], v1 offset:35840
    s_waitcnt lgkmcnt(6)
    v_mfma_f32_32x32x16_bf16 v[40:55], v[128:131], v[60:63], 0
    s_add_u32 s49, s16, 0
    buffer_load_dwordx4 v[128:131], v1, s[24:27], s49 offen sc1
    s_waitcnt lgkmcnt(5)
    v_mfma_f32_32x32x16_bf16 v[24:39], v[132:135], v[64:67], v[24:39]
    ds_read_b128 v[56:59], v1 offset:4096
    ds_read_b128 v[60:63], v1 offset:36864
    s_waitcnt lgkmcnt(6)
    v_mfma_f32_32x32x16_bf16 v[40:55], v[132:135], v[68:71], v[40:55]
    s_add_u32 s49, s16, 114688
    buffer_load_dwordx4 v[132:135], v1, s[24:27], s49 offen sc1
    s_waitcnt lgkmcnt(5)
    v_mfma_f32_32x32x16_bf16 v[24:39], v[136:139], v[72:75], v[24:39]
    ds_read_b128 v[64:67], v1 offset:5120
    ds_read_b128 v[68:71], v1 offset:37888
    s_waitcnt lgkmcnt(6)
    v_mfma_f32_32x32x16_bf16 v[40:55], v[136:139], v[76:79], v[40:55]
    s_add_u32 s49, s16, 1024
    buffer_load_dwordx4 v[136:139], v1, s[24:27], s49 offen sc1
    s_waitcnt lgkmcnt(5)
    v_mfma_f32_32x32x16_bf16 v[24:39], v[140:143], v[80:83], v[24:39]
    ds_read_b128 v[72:75], v1 offset:6144
    ds_read_b128 v[76:79], v1 offset:38912
    s_waitcnt lgkmcnt(6)
    v_mfma_f32_32x32x16_bf16 v[40:55], v[140:143], v[84:87], v[40:55]
    s_add_u32 s49, s16, 115712
    buffer_load_dwordx4 v[140:143], v1, s[24:27], s49 offen sc1
    s_waitcnt lgkmcnt(5)
    v_mfma_f32_32x32x16_bf16 v[24:39], v[144:147], v[56:59], v[24:39]
    ds_read_b128 v[80:83], v1 offset:7168
    ds_read_b128 v[84:87], v1 offset:39936
    s_waitcnt lgkmcnt(6)
    v_mfma_f32_32x32x16_bf16 v[40:55], v[144:147], v[60:63], v[40:55]
    s_add_u32 s49, s16, 2048
    buffer_load_dwordx4 v[144:147], v1, s[24:27], s49 offen sc1
    s_waitcnt lgkmcnt(5)
    v_mfma_f32_32x32x16_bf16 v[24:39], v[148:151], v[64:67], v[24:39]
    ds_read_b128 v[56:59], v1 offset:8192
    ds_read_b128 v[60:63], v1 offset:40960
    s_waitcnt lgkmcnt(6)
    v_mfma_f32_32x32x16_bf16 v[40:55], v[148:151], v[68:71], v[40:55]
    s_add_u32 s49, s16, 116736
    buffer_load_dwordx4 v[148:151], v1, s[24:27], s49 offen sc1
    s_waitcnt lgkmcnt(5)
    v_mfma_f32_32x32x16_bf16 v[24:39], v[152:155], v[72:75], v[24:39]
    ds_read_b128 v[64:67], v1 offset:9216
    ds_read_b128 v[68:71], v1 offset:41984
    s_waitcnt lgkmcnt(6)
    v_mfma_f32_32x32x16_bf16 v[40:55], v[152:155], v[76:79], v[40:55]
    s_add_u32 s49, s16, 3072
    buffer_load_dwordx4 v[152:155], v1, s[24:27], s49 offen sc1
    s_waitcnt lgkmcnt(5)
    v_mfma_f32_32x32x16_bf16 v[24:39], v[156:159], v[80:83], v[24:39]
    ds_read_b128 v[72:75], v1 offset:10240
    ds_read_b128 v[76:79], v1 offset:43008
    s_waitcnt lgkmcnt(6)
    v_mfma_f32_32x32x16_bf16 v[40:55], v[156:159], v[84:87], v[40:55]
    s_add_u32 s49, s16, 117760
    buffer_load_dwordx4 v[156:159], v1, s[24:27], s49 offen sc1
    s_waitcnt lgkmcnt(5)
    v_mfma_f32_32x32x16_bf16 v[24:39], v[160:163], v[56:59], v[24:39]
    ds_read_b128 v[80:83], v1 offset:11264
    ds_read_b128 v[84:87], v1 offset:44032
    s_waitcnt lgkmcnt(6)
    v_mfma_f32_32x32x16_bf16 v[40:55], v[160:163], v[60:63], v[40:55]
    s_add_u32 s49, s16, 4096
    buffer_load_dwordx4 v[160:163], v1, s[24:27], s49 offen sc1
    s_waitcnt lgkmcnt(5)
    v_mfma_f32_32x32x16_bf16 v[24:39], v[164:167], v[64:67], v[24:39]
    ds_read_b128 v[56:59], v1 offset:12288
    ds_read_b128 v[60:63], v1 offset:45056
    s_waitcnt lgkmcnt(6)
    v_mfma_f32_32x32x16_bf16 v[40:55], v[164:167], v[68:71], v[40:55]
    s_add_u32 s49, s16, 118784
    buffer_load_dwordx4 v[164:167], v1, s[24:27], s49 offen sc1
    s_waitcnt lgkmcnt(5)
    v_mfma_f32_32x32x16_bf16 v[24:39], v[168:171], v[72:75], v[24:39]
    ds_read_b128 v[64:67], v1 offset:13312
    ds_read_b128 v[68:71], v1 offset:46080
    s_waitcnt lgkmcnt(6)
    v_mfma_f32_32x32x16_bf16 v[40:55], v[168:171], v[76:79], v[40:55]
    s_add_u32 s49, s16, 5120
    buffer_load_dwordx4 v[168:171], v1, s[24:27], s49 offen sc1
    s_waitcnt lgkmcnt(5)
    v_mfma_f32_32x32x16_bf16 v[24:39], v[172:175], v[80:83], v[24:39]
    ds_read_b128 v[72:75], v1 offset:14336
    ds_read_b128 v[76:79], v1 offset:47104
    s_waitcnt lgkmcnt(6)
    v_mfma_f32_32x32x16_bf16 v[40:55], v[172:175], v[84:87], v[40:55]
    s_add_u32 s49, s16, 119808
    buffer_load_dwordx4 v[172:175], v1, s[24:27], s49 offen sc1
    s_waitcnt lgkmcnt(5)
    v_mfma_f32_32x32x16_bf16 v[24:39], v[176:179], v[56:59], v[24:39]
    ds_read_b128 v[80:83], v1 offset:15360
    ds_read_b128 v[84:87], v1 offset:48128
    s_waitcnt lgkmcnt(6)
    v_mfma_f32_32x32x16_bf16 v[40:55], v[176:179], v[60:63], v[40:55]
    s_add_u32 s49, s16, 6144
    buffer_load_dwordx4 v[176:179], v1, s[24:27], s49 offen sc1
    s_waitcnt vmcnt(13)
    s_barrier
    s_waitcnt lgkmcnt(5)
    v_mfma_f32_32x32x16_bf16 v[24:39], v[180:183], v[64:67], v[24:39]
    ds_read_b128 v[56:59], v1 offset:16384
    ds_read_b128 v[60:63], v1 offset:49152
    s_waitcnt lgkmcnt(6)
    v_mfma_f32_32x32x16_bf16 v[40:55], v[180:183], v[68:71], v[40:55]
    s_add_u32 s49, s16, 120832
    buffer_load_dwordx4 v[180:183], v1, s[24:27], s49 offen sc1
    s_waitcnt lgkmcnt(5)
    v_mfma_f32_32x32x16_bf16 v[24:39], v[184:187], v[72:75], v[24:39]
    ds_read_b128 v[64:67], v1 offset:17408
    ds_read_b128 v[68:71], v1 offset:50176
    s_waitcnt lgkmcnt(6)
    v_mfma_f32_32x32x16_bf16 v[40:55], v[184:187], v[76:79], v[40:55]
    s_add_u32 s49, s16, 7168
    buffer_load_dwordx4 v[184:187], v1, s[24:27], s49 offen sc1
    s_waitcnt lgkmcnt(5)
    v_mfma_f32_32x32x16_bf16 v[24:39], v[188:191], v[80:83], v[24:39]
    ds_read_b128 v[72:75], v1 offset:18432
    ds_read_b128 v[76:79], v1 offset:51200
    s_waitcnt lgkmcnt(6)
    v_mfma_f32_32x32x16_bf16 v[40:55], v[188:191], v[84:87], v[40:55]
    s_add_u32 s49, s16, 121856
    buffer_load_dwordx4 v[188:191], v1, s[24:27], s49 offen sc1
    s_waitcnt lgkmcnt(5)
    v_mfma_f32_32x32x16_bf16 v[24:39], v[192:195], v[56:59], v[24:39]
    ds_read_b128 v[80:83], v1 offset:19456
    ds_read_b128 v[84:87], v1 offset:52224
    s_waitcnt lgkmcnt(6)
    v_mfma_f32_32x32x16_bf16 v[40:55], v[192:195], v[60:63], v[40:55]
    s_add_u32 s49, s16, 8192
    buffer_load_dwordx4 v[192:195], v1, s[24:27], s49 offen sc1
    s_waitcnt lgkmcnt(5)
    v_mfma_f32_32x32x16_bf16 v[24:39], v[196:199], v[64:67], v[24:39]
    ds_read_b128 v[56:59], v1 offset:20480
    ds_read_b128 v[60:63], v1 offset:53248
    s_waitcnt lgkmcnt(6)
    v_mfma_f32_32x32x16_bf16 v[40:55], v[196:199], v[68:71], v[40:55]
    s_add_u32 s49, s16, 122880
    buffer_load_dwordx4 v[196:199], v1, s[24:27], s49 offen sc1
    s_waitcnt lgkmcnt(5)
    v_mfma_f32_32x32x16_bf16 v[24:39], v[200:203], v[72:75], v[24:39]
    ds_read_b128 v[64:67], v1 offset:21504
    ds_read_b128 v[68:71], v1 offset:54272
    s_waitcnt lgkmcnt(6)
    v_mfma_f32_32x32x16_bf16 v[40:55], v[200:203], v[76:79], v[40:55]
    s_add_u32 s49, s16, 9216
    buffer_load_dwordx4 v[200:203], v1, s[24:27], s49 offen sc1
    s_waitcnt lgkmcnt(5)
    v_mfma_f32_32x32x16_bf16 v[24:39], v[204:207], v[80:83], v[24:39]
    ds_read_b128 v[72:75], v1 offset:22528
    ds_read_b128 v[76:79], v1 offset:55296
    s_waitcnt lgkmcnt(6)
    v_mfma_f32_32x32x16_bf16 v[40:55], v[204:207], v[84:87], v[40:55]
    s_add_u32 s49, s16, 123904
    buffer_load_dwordx4 v[204:207], v1, s[24:27], s49 offen sc1
    s_waitcnt lgkmcnt(5)
    v_mfma_f32_32x32x16_bf16 v[24:39], v[208:211], v[56:59], v[24:39]
    ds_read_b128 v[80:83], v1 offset:23552
    ds_read_b128 v[84:87], v1 offset:56320
    s_waitcnt lgkmcnt(6)
    v_mfma_f32_32x32x16_bf16 v[40:55], v[208:211], v[60:63], v[40:55]
    s_add_u32 s49, s16, 10240
    buffer_load_dwordx4 v[208:211], v1, s[24:27], s49 offen sc1
    s_waitcnt lgkmcnt(5)
    v_mfma_f32_32x32x16_bf16 v[24:39], v[212:215], v[64:67], v[24:39]
    ds_read_b128 v[56:59], v1 offset:24576
    ds_read_b128 v[60:63], v1 offset:57344
    s_waitcnt lgkmcnt(6)
    v_mfma_f32_32x32x16_bf16 v[40:55], v[212:215], v[68:71], v[40:55]
    s_add_u32 s49, s16, 124928
    buffer_load_dwordx4 v[212:215], v1, s[24:27], s49 offen sc1
    s_waitcnt lgkmcnt(5)
    v_mfma_f32_32x32x16_bf16 v[24:39], v[216:219], v[72:75], v[24:39]
    ds_read_b128 v[64:67], v1 offset:25600
    ds_read_b128 v[68:71], v1 offset:58368
    s_waitcnt lgkmcnt(6)
    v_mfma_f32_32x32x16_bf16 v[40:55], v[216:219], v[76:79], v[40:55]
    s_add_u32 s49, s16, 11264
    buffer_load_dwordx4 v[216:219], v1, s[24:27], s49 offen sc1
    s_waitcnt lgkmcnt(5)
    v_mfma_f32_32x32x16_bf16 v[24:39], v[220:223], v[80:83], v[24:39]
    ds_read_b128 v[72:75], v1 offset:26624
    ds_read_b128 v[76:79], v1 offset:59392
    s_waitcnt lgkmcnt(6)
    v_mfma_f32_32x32x16_bf16 v[40:55], v[220:223], v[84:87], v[40:55]
    s_add_u32 s49, s16, 125952
    buffer_load_dwordx4 v[220:223], v1, s[24:27], s49 offen sc1
    s_waitcnt lgkmcnt(5)
    v_mfma_f32_32x32x16_bf16 v[24:39], v[224:227], v[56:59], v[24:39]
    ds_read_b128 v[80:83], v1 offset:27648
    ds_read_b128 v[84:87], v1 offset:60416
    s_waitcnt lgkmcnt(6)
    v_mfma_f32_32x32x16_bf16 v[40:55], v[224:227], v[60:63], v[40:55]
    s_add_u32 s49, s16, 12288
    buffer_load_dwordx4 v[224:227], v1, s[24:27], s49 offen sc1
    s_waitcnt lgkmcnt(5)
    v_mfma_f32_32x32x16_bf16 v[24:39], v[228:231], v[64:67], v[24:39]
    ds_read_b128 v[56:59], v1 offset:28672
    ds_read_b128 v[60:63], v1 offset:61440
    s_waitcnt lgkmcnt(6)
    v_mfma_f32_32x32x16_bf16 v[40:55], v[228:231], v[68:71], v[40:55]
    s_add_u32 s49, s16, 126976
    buffer_load_dwordx4 v[228:231], v1, s[24:27], s49 offen sc1
    s_waitcnt lgkmcnt(5)
    v_mfma_f32_32x32x16_bf16 v[24:39], v[232:235], v[72:75], v[24:39]
    ds_read_b128 v[64:67], v1 offset:29696
    ds_read_b128 v[68:71], v1 offset:62464
    s_waitcnt lgkmcnt(6)
    v_mfma_f32_32x32x16_bf16 v[40:55], v[232:235], v[76:79], v[40:55]
    s_add_u32 s49, s16, 13312
    buffer_load_dwordx4 v[232:235], v1, s[24:27], s49 offen sc1
    s_waitcnt lgkmcnt(5)
    v_mfma_f32_32x32x16_bf16 v[24:39], v[236:239], v[80:83], v[24:39]
    ds_read_b128 v[72:75], v1 offset:30720
    ds_read_b128 v[76:79], v1 offset:63488
    s_waitcnt lgkmcnt(6)
    v_mfma_f32_32x32x16_bf16 v[40:55], v[236:239], v[84:87], v[40:55]
    s_add_u32 s49, s16, 128000
    buffer_load_dwordx4 v[236:239], v1, s[24:27], s49 offen sc1
    s_waitcnt lgkmcnt(5)
    v_mfma_f32_32x32x16_bf16 v[24:39], v[240:243], v[56:59], v[24:39]
    ds_read_b128 v[80:83], v1 offset:31744
    ds_read_b128 v[84:87], v1 offset:64512
    s_waitcnt lgkmcnt(6)
    v_mfma_f32_32x32x16_bf16 v[40:55], v[240:243], v[60:63], v[40:55]
    s_waitcnt lgkmcnt(5)
    v_mfma_f32_32x32x16_bf16 v[24:39], v[244:247], v[64:67], v[24:39]
    s_waitcnt lgkmcnt(4)
    v_mfma_f32_32x32x16_bf16 v[40:55], v[244:247], v[68:71], v[40:55]
    s_waitcnt lgkmcnt(3)
    v_mfma_f32_32x32x16_bf16 v[24:39], v[248:251], v[72:75], v[24:39]
    s_waitcnt lgkmcnt(2)
    v_mfma_f32_32x32x16_bf16 v[40:55], v[248:251], v[76:79], v[40:55]
    s_waitcnt lgkmcnt(0)
    ds_read_b32 v120, v6 offset:1024
    ds_read_b32 v121, v6 offset:1152
    ds_read_b32 v122, v7 offset:1280
    ds_read_b128 v[88:91], v2 offset:0
    ds_read_b128 v[92:95], v2 offset:32
    ds_read_b128 v[96:99], v2 offset:64
    ds_read_b128 v[100:103], v2 offset:96
    v_mfma_f32_32x32x16_bf16 v[24:39], v[252:255], v[80:83], v[24:39]
    v_mfma_f32_32x32x16_bf16 v[40:55], v[252:255], v[84:87], v[40:55]
    s_add_u32 s49, s60, 114688
    v_mov_b32 v3, 0
    s_nop 8
    s_waitcnt lgkmcnt(0)
    v_fma_f32 v24, -v120, v88, v24
    v_fma_f32 v25, -v120, v89, v25
    v_fma_f32 v26, -v120, v90, v26
    v_fma_f32 v27, -v120, v91, v27
    v_fma_f32 v28, -v120, v92, v28
    v_fma_f32 v29, -v120, v93, v29
    v_fma_f32 v30, -v120, v94, v30
    v_fma_f32 v31, -v120, v95, v31
    v_fma_f32 v32, -v120, v96, v32
    v_fma_f32 v33, -v120, v97, v33
    v_fma_f32 v34, -v120, v98, v34
    v_fma_f32 v35, -v120, v99, v35
    v_fma_f32 v36, -v120, v100, v36
    v_fma_f32 v37, -v120, v101, v37
    v_fma_f32 v38, -v120, v102, v38
    v_fma_f32 v39, -v120, v103, v39
    v_cvt_pk_bf16_f32 v24, v24, v25
    v_cvt_pk_bf16_f32 v25, v26, v27
    v_cvt_pk_bf16_f32 v26, v28, v29
    v_cvt_pk_bf16_f32 v27, v30, v31
    v_cvt_pk_bf16_f32 v28, v32, v33
    v_cvt_pk_bf16_f32 v29, v34, v35
    v_cvt_pk_bf16_f32 v30, v36, v37
    v_cvt_pk_bf16_f32 v31, v38, v39
    v_pk_max_i16 v24, v24, v3
    v_pk_max_i16 v25, v25, v3
    v_pk_max_i16 v26, v26, v3
    v_pk_max_i16 v27, v27, v3
    v_pk_max_i16 v28, v28, v3
    v_pk_max_i16 v29, v29, v3
    v_pk_max_i16 v30, v30, v3
    v_pk_max_i16 v31, v31, v3
    s_cmp_lg_u32 s70, 0
    s_cbranch_scc1 L_stl_sequen_40
    buffer_store_dwordx4 v[24:27], v1, s[24:27], s60 offen sc1
    buffer_store_dwordx4 v[28:31], v1, s[24:27], s60 offen offset:1024 sc1
    s_branch L_stj_sequen_41
L_stl_sequen_40:
    buffer_store_dwordx4 v[24:27], v1, s[24:27], s60 offen
    buffer_store_dwordx4 v[28:31], v1, s[24:27], s60 offen offset:1024
L_stj_sequen_41:
    v_fma_f32 v40, -v121, v88, v40
    v_fma_f32 v41, -v121, v89, v41
    v_fma_f32 v42, -v121, v90, v42
    v_fma_f32 v43, -v121, v91, v43
    v_fma_f32 v44, -v121, v92, v44
    v_fma_f32 v45, -v121, v93, v45
    v_fma_f32 v46, -v121, v94, v46
    v_fma_f32 v47, -v121, v95, v47
    v_fma_f32 v48, -v121, v96, v48
    v_fma_f32 v49, -v121, v97, v49
    v_fma_f32 v50, -v121, v98, v50
    v_fma_f32 v51, -v121, v99, v51
    v_fma_f32 v52, -v121, v100, v52
    v_fma_f32 v53, -v121, v101, v53
    v_fma_f32 v54, -v121, v102, v54
    v_fma_f32 v55, -v121, v103, v55
    v_cvt_pk_bf16_f32 v40, v40, v41
    v_cvt_pk_bf16_f32 v41, v42, v43
    v_cvt_pk_bf16_f32 v42, v44, v45
    v_cvt_pk_bf16_f32 v43, v46, v47
    v_cvt_pk_bf16_f32 v44, v48, v49
    v_cvt_pk_bf16_f32 v45, v50, v51
    v_cvt_pk_bf16_f32 v46, v52, v53
    v_cvt_pk_bf16_f32 v47, v54, v55
    v_pk_max_i16 v40, v40, v3
    v_pk_max_i16 v41, v41, v3
    v_pk_max_i16 v42, v42, v3
    v_pk_max_i16 v43, v43, v3
    v_pk_max_i16 v44, v44, v3
    v_pk_max_i16 v45, v45, v3
    v_pk_max_i16 v46, v46, v3
    v_pk_max_i16 v47, v47, v3
    s_cmp_lg_u32 s70, 0
    s_cbranch_scc1 L_stl_sequen_42
    buffer_store_dwordx4 v[40:43], v1, s[24:27], s49 offen sc1
    buffer_store_dwordx4 v[44:47], v1, s[24:27], s49 offen offset:1024 sc1
    s_branch L_stj_sequen_43
L_stl_sequen_42:
    buffer_store_dwordx4 v[40:43], v1, s[24:27], s49 offen
    buffer_store_dwordx4 v[44:47], v1, s[24:27], s49 offen offset:1024
L_stj_sequen_43:
    s_branch L_p4e
L_w7:
    v_lshrrev_b32 v6, 4, v1
    v_and_b32 v2, 31, v6
    v_lshlrev_b32 v2, 3, v2
    v_lshrrev_b32 v6, 5, v6
    v_lshl_add_u32 v2, v6, 12, v2
    s_lshl_b32 s48, s5, 14
    s_add_u32 s48, s48, 0x1600000
    buffer_load_dwordx2 v[24:25], v2, s[24:27], s48 offen offset:0 sc1
    buffer_load_dwordx2 v[26:27], v2, s[24:27], s48 offen offset:256 sc1
    buffer_load_dwordx2 v[28:29], v2, s[24:27], s48 offen offset:512 sc1
    buffer_load_dwordx2 v[30:31], v2, s[24:27], s48 offen offset:768 sc1
    buffer_load_dwordx2 v[32:33], v2, s[24:27], s48 offen offset:1024 sc1
    buffer_load_dwordx2 v[34:35], v2, s[24:27], s48 offen offset:1280 sc1
    buffer_load_dwordx2 v[36:37], v2, s[24:27], s48 offen offset:1536 sc1
    buffer_load_dwordx2 v[38:39], v2, s[24:27], s48 offen offset:1792 sc1
    buffer_load_dwordx2 v[40:41], v2, s[24:27], s48 offen offset:2048 sc1
    buffer_load_dwordx2 v[42:43], v2, s[24:27], s48 offen offset:2304 sc1
    buffer_load_dwordx2 v[44:45], v2, s[24:27], s48 offen offset:2560 sc1
    buffer_load_dwordx2 v[46:47], v2, s[24:27], s48 offen offset:2816 sc1
    buffer_load_dwordx2 v[48:49], v2, s[24:27], s48 offen offset:3072 sc1
    buffer_load_dwordx2 v[50:51], v2, s[24:27], s48 offen offset:3328 sc1
    buffer_load_dwordx2 v[52:53], v2, s[24:27], s48 offen offset:3584 sc1
    buffer_load_dwordx2 v[54:55], v2, s[24:27], s48 offen offset:3840 sc1
    s_add_u32 s48, s48, 8192
    buffer_load_dwordx2 v[56:57], v2, s[24:27], s48 offen offset:0 sc1
    buffer_load_dwordx2 v[58:59], v2, s[24:27], s48 offen offset:256 sc1
    buffer_load_dwordx2 v[60:61], v2, s[24:27], s48 offen offset:512 sc1
    buffer_load_dwordx2 v[62:63], v2, s[24:27], s48 offen offset:768 sc1
    buffer_load_dwordx2 v[64:65], v2, s[24:27], s48 offen offset:1024 sc1
    buffer_load_dwordx2 v[66:67], v2, s[24:27], s48 offen offset:1280 sc1
    buffer_load_dwordx2 v[68:69], v2, s[24:27], s48 offen offset:1536 sc1
    buffer_load_dwordx2 v[70:71], v2, s[24:27], s48 offen offset:1792 sc1
    buffer_load_dwordx2 v[72:73], v2, s[24:27], s48 offen offset:2048 sc1
    buffer_load_dwordx2 v[74:75], v2, s[24:27], s48 offen offset:2304 sc1
    buffer_load_dwordx2 v[76:77], v2, s[24:27], s48 offen offset:2560 sc1
    buffer_load_dwordx2 v[78:79], v2, s[24:27], s48 offen offset:2816 sc1
    buffer_load_dwordx2 v[80:81], v2, s[24:27], s48 offen offset:3072 sc1
    buffer_load_dwordx2 v[82:83], v2, s[24:27], s48 offen offset:3328 sc1
    buffer_load_dwordx2 v[84:85], v2, s[24:27], s48 offen offset:3584 sc1
    buffer_load_dwordx2 v[86:87], v2, s[24:27], s48 offen offset:3840 sc1
    s_barrier
    s_waitcnt vmcnt(0)
    v_lshrrev_b32 v6, 4, v1
    v_and_b32 v6, 31, v6
    v_lshlrev_b32 v6, 2, v6
    v_add_f32 v24, v24, v40
    v_add_f32 v25, v25, v41
    v_add_f32 v26, v26, v42
    v_add_f32 v27, v27, v43
    v_add_f32 v28, v28, v44
    v_add_f32 v29, v29, v45
    v_add_f32 v30, v30, v46
    v_add_f32 v31, v31, v47
    v_add_f32 v32, v32, v48
    v_add_f32 v33, v33, v49
    v_add_f32 v34, v34, v50
    v_add_f32 v35, v35, v51
    v_add_f32 v36, v36, v52
    v_add_f32 v37, v37, v53
    v_add_f32 v38, v38, v54
    v_add_f32 v39, v39, v55
    v_add_f32 v24, v24, v32
    v_add_f32 v25, v25, v33
    v_add_f32 v26, v26, v34
    v_add_f32 v27, v27, v35
    v_add_f32 v28, v28, v36
    v_add_f32 v29, v29, v37
    v_add_f32 v30, v30, v38
    v_add_f32 v31, v31, v39
    v_add_f32 v24, v24, v28
    v_add_f32 v25, v25, v29
    v_add_f32 v26, v26, v30
    v_add_f32 v27, v27, v31
    v_add_f32 v24, v24, v26
    v_add_f32 v25, v25, v27
    v_mov_b32 v26, v24
    v_mov_b32 v27, v25
    s_nop 1
    v_permlane32_swap_b32 v24, v26
    v_permlane32_swap_b32 v25, v27
    v_add_f32 v24, v24, v26
    v_add_f32 v25, v25, v27
    v_mul_f32 v24, 0x3b000000, v24
    v_mul_f32 v25, 0x3b000000, v25
    v_fma_f32 v25, -v24, v24, v25
    v_max_f32 v25, 0, v25
    v_add_f32 v25, 0x3727c5ac, v25
    v_rsq_f32 v25, v25
    v_add_u32 v7, 147456, v6
    ds_write_b32 v7, v24 offset:1024
    ds_write_b32 v7, v25 offset:1280
    v_add_f32 v56, v56, v72
    v_add_f32 v57, v57, v73
    v_add_f32 v58, v58, v74
    v_add_f32 v59, v59, v75
    v_add_f32 v60, v60, v76
    v_add_f32 v61, v61, v77
    v_add_f32 v62, v62, v78
    v_add_f32 v63, v63, v79
    v_add_f32 v64, v64, v80
    v_add_f32 v65, v65, v81
    v_add_f32 v66, v66, v82
    v_add_f32 v67, v67, v83
    v_add_f32 v68, v68, v84
    v_add_f32 v69, v69, v85
    v_add_f32 v70, v70, v86
    v_add_f32 v71, v71, v87
    v_add_f32 v56, v56, v64
    v_add_f32 v57, v57, v65
    v_add_f32 v58, v58, v66
    v_add_f32 v59, v59, v67
    v_add_f32 v60, v60, v68
    v_add_f32 v61, v61, v69
    v_add_f32 v62, v62, v70
    v_add_f32 v63, v63, v71
    v_add_f32 v56, v56, v60
    v_add_f32 v57, v57, v61
    v_add_f32 v58, v58, v62
    v_add_f32 v59, v59, v63
    v_add_f32 v56, v56, v58
    v_add_f32 v57, v57, v59
    v_mov_b32 v58, v56
    v_mov_b32 v59, v57
    s_nop 1
    v_permlane32_swap_b32 v56, v58
    v_permlane32_swap_b32 v57, v59
    v_add_f32 v56, v56, v58
    v_add_f32 v57, v57, v59
    v_mul_f32 v56, 0x3b000000, v56
    v_mul_f32 v57, 0x3b000000, v57
    v_fma_f32 v57, -v56, v56, v57
    v_max_f32 v57, 0, v57
    v_add_f32 v57, 0x3727c5ac, v57
    v_rsq_f32 v57, v57
    v_add_u32 v7, 147584, v6
    ds_write_b32 v7, v56 offset:1024
    ds_write_b32 v7, v57 offset:1280
    s_lshl_b32 s48, s9, 7
    s_add_u32 s48, s48, 147456
    v_add_u32 v7, s48, v6
    s_waitcnt lgkmcnt(0)
    s_barrier
    ds_read_b32 v122, v7 offset:1280
L_p4e:
    s_add_u32 s18, s18, 0x8000
    v_lshrrev_b32 v6, 1, v1
    s_waitcnt lgkmcnt(0)
    s_waitcnt vmcnt(0)
    s_barrier
    s_cmp_lg_u32 s22, 0
    s_cbranch_scc1 L_w0_sequen_44
    s_mov_b64 exec, 0xffff
    s_cmp_lg_u32 s70, 0
    s_cbranch_scc1 L_stl_sequen_45
    buffer_store_dwordx2 v[4:5], v6, s[24:27], s18 offen sc1
    s_branch L_stj_sequen_46
L_stl_sequen_45:
    buffer_store_dwordx2 v[4:5], v6, s[24:27], s18 offen
L_stj_sequen_46:
    s_mov_b64 exec, -1
L_w0_sequen_44:
    s_cmp_lg_u32 s22, 0
    s_cbranch_scc1 L_w0_sequen_47
    v_lshlrev_b32 v6, 3, v1
    s_lshl_b32 s48, s5, 10
    s_add_u32 s48, s48, 0x17b0000
    s_mov_b32 s51, 0
    s_mov_b32 exec_hi, 0
    s_mov_b32 exec_lo, 0xff
L_poll_sequen_48:
    buffer_load_dwordx2 v[2:3], v6, s[24:27], s48 offen sc1
    s_add_u32 s51, s51, 1
    s_waitcnt vmcnt(0)
    v_cmp_eq_u64 vcc, v[2:3], v[4:5]
    s_cmp_gt_u32 s51, 400000
    s_cbranch_scc1 L_pdone_sequen_49
    s_cmp_eq_u64 vcc, exec
    s_cbranch_scc0 L_poll_sequen_48
L_pdone_sequen_49:
    s_mov_b64 exec, -1
L_w0_sequen_47:
    s_barrier
    s_mul_i32 s48, s5, 224
    s_mul_i32 s49, s22, 14
    s_add_u32 s48, s48, s49
    s_lshl_b32 s48, s48, 10
    s_add_u32 s48, s48, 0xf00000
    s_add_u32 s49, s48, 0
    buffer_load_dwordx4 v[12:15], v1, s[24:27], s49 offen sc1
    s_add_u32 s49, s48, 114688
    buffer_load_dwordx4 v[16:19], v1, s[24:27], s49 offen sc1
    s_add_u32 s49, s48, 1024
    buffer_load_dwordx4 v[20:23], v1, s[24:27], s49 offen sc1
    s_add_u32 s49, s48, 115712
    buffer_load_dwordx4 v[24:27], v1, s[24:27], s49 offen sc1
    s_add_u32 s49, s48, 2048
    buffer_load_dwordx4 v[28:31], v1, s[24:27], s49 offen sc1
    s_add_u32 s49, s48, 116736
    buffer_load_dwordx4 v[32:35], v1, s[24:27], s49 offen sc1
    s_add_u32 s49, s48, 3072
    buffer_load_dwordx4 v[36:39], v1, s[24:27], s49 offen sc1
    s_add_u32 s49, s48, 117760
    buffer_load_dwordx4 v[40:43], v1, s[24:27], s49 offen sc1
    s_add_u32 s49, s48, 4096
    buffer_load_dwordx4 v[44:47], v1, s[24:27], s49 offen sc1
    s_add_u32 s49, s48, 118784
    buffer_load_dwordx4 v[48:51], v1, s[24:27], s49 offen sc1
    s_add_u32 s49, s48, 5120
    buffer_load_dwordx4 v[52:55], v1, s[24:27], s49 offen sc1
    s_add_u32 s49, s48, 119808
    buffer_load_dwordx4 v[240:243], v1, s[24:27], s49 offen sc1
    s_add_u32 s49, s48, 6144
    buffer_load_dwordx4 v[244:247], v1, s[24:27], s49 offen sc1
    s_add_u32 s49, s48, 120832
    buffer_load_dwordx4 v[248:251], v1, s[24:27], s49 offen sc1
    s_waitcnt vmcnt(13)
    v_mfma_f32_32x32x16_bf16 v[56:71], v[128:131], v[12:15], 0
    v_mfma_f32_32x32x16_bf16 v[88:103], v[132:135], v[12:15], 0
    s_add_u32 s49, s48, 7168
    buffer_load_dwordx4 v[12:15], v1, s[24:27], s49 offen sc1
    s_waitcnt vmcnt(13)
    v_mfma_f32_32x32x16_bf16 v[72:87], v[128:131], v[16:19], 0
    v_mfma_f32_32x32x16_bf16 v[104:119], v[132:135], v[16:19], 0
    s_add_u32 s49, s48, 121856
    buffer_load_dwordx4 v[16:19], v1, s[24:27], s49 offen sc1
    s_waitcnt vmcnt(13)
    v_mfma_f32_32x32x16_bf16 v[56:71], v[136:139], v[20:23], v[56:71]
    v_mfma_f32_32x32x16_bf16 v[88:103], v[140:143], v[20:23], v[88:103]
    s_add_u32 s49, s48, 8192
    buffer_load_dwordx4 v[20:23], v1, s[24:27], s49 offen sc1
    s_waitcnt vmcnt(13)
    v_mfma_f32_32x32x16_bf16 v[72:87], v[136:139], v[24:27], v[72:87]
    v_mfma_f32_32x32x16_bf16 v[104:119], v[140:143], v[24:27], v[104:119]
    s_add_u32 s49, s48, 122880
    buffer_load_dwordx4 v[24:27], v1, s[24:27], s49 offen sc1
    s_waitcnt vmcnt(13)
    v_mfma_f32_32x32x16_bf16 v[56:71], v[144:147], v[28:31], v[56:71]
    v_mfma_f32_32x32x16_bf16 v[88:103], v[148:151], v[28:31], v[88:103]
    s_add_u32 s49, s48, 9216
    buffer_load_dwordx4 v[28:31], v1, s[24:27], s49 offen sc1
    s_waitcnt vmcnt(13)
    v_mfma_f32_32x32x16_bf16 v[72:87], v[144:147], v[32:35], v[72:87]
    v_mfma_f32_32x32x16_bf16 v[104:119], v[148:151], v[32:35], v[104:119]
    s_add_u32 s49, s48, 123904
    buffer_load_dwordx4 v[32:35], v1, s[24:27], s49 offen sc1
    s_waitcnt vmcnt(13)
    v_mfma_f32_32x32x16_bf16 v[56:71], v[152:155], v[36:39], v[56:71]
    v_mfma_f32_32x32x16_bf16 v[88:103], v[156:159], v[36:39], v[88:103]
    s_add_u32 s49, s48, 10240
    buffer_load_dwordx4 v[36:39], v1, s[24:27], s49 offen sc1
    s_waitcnt vmcnt(13)
    v_mfma_f32_32x32x16_bf16 v[72:87], v[152:155], v[40:43], v[72:87]
    v_mfma_f32_32x32x16_bf16 v[104:119], v[156:159], v[40:43], v[104:119]
    s_add_u32 s49, s48, 124928
    buffer_load_dwordx4 v[40:43], v1, s[24:27], s49 offen sc1
    s_waitcnt vmcnt(13)
    v_mfma_f32_32x32x16_bf16 v[56:71], v[160:163], v[44:47], v[56:71]
    v_mfma_f32_32x32x16_bf16 v[88:103], v[164:167], v[44:47], v[88:103]
    s_add_u32 s49, s48, 11264
    buffer_load_dwordx4 v[44:47], v1, s[24:27], s49 offen sc1
    s_waitcnt vmcnt(13)
    v_mfma_f32_32x32x16_bf16 v[72:87], v[160:163], v[48:51], v[72:87]
    v_mfma_f32_32x32x16_bf16 v[104:119], v[164:167], v[48:51], v[104:119]
    s_add_u32 s49, s48, 125952
    buffer_load_dwordx4 v[48:51], v1, s[24:27], s49 offen sc1
    s_waitcnt vmcnt(13)
    v_mfma_f32_32x32x16_bf16 v[56:71], v[168:171], v[52:55], v[56:71]
    v_mfma_f32_32x32x16_bf16 v[88:103], v[172:175], v[52:55], v[88:103]
    s_add_u32 s49, s48, 12288
    buffer_load_dwordx4 v[52:55], v1, s[24:27], s49 offen sc1
    s_waitcnt vmcnt(13)
    v_mfma_f32_32x32x16_bf16 v[72:87], v[168:171], v[240:243], v[72:87]
    v_mfma_f32_32x32x16_bf16 v[104:119], v[172:175], v[240:243], v[104:119]
    s_add_u32 s49, s48, 126976
    buffer_load_dwordx4 v[240:243], v1, s[24:27], s49 offen sc1
    s_waitcnt vmcnt(13)
    v_mfma_f32_32x32x16_bf16 v[56:71], v[176:179], v[244:247], v[56:71]
    v_mfma_f32_32x32x16_bf16 v[88:103], v[180:183], v[244:247], v[88:103]
    s_add_u32 s49, s48, 13312
    buffer_load_dwordx4 v[244:247], v1, s[24:27], s49 offen sc1
    s_waitcnt vmcnt(13)
    v_mfma_f32_32x32x16_bf16 v[72:87], v[176:179], v[248:251], v[72:87]
    v_mfma_f32_32x32x16_bf16 v[104:119], v[180:183], v[248:251], v[104:119]
    s_add_u32 s49, s48, 128000
    buffer_load_dwordx4 v[248:251], v1, s[24:27], s49 offen sc1
    s_waitcnt vmcnt(13)
    v_mfma_f32_32x32x16_bf16 v[56:71], v[184:187], v[12:15], v[56:71]
    v_mfma_f32_32x32x16_bf16 v[88:103], v[188:191], v[12:15], v[88:103]
    s_waitcnt vmcnt(12)
    v_mfma_f32_32x32x16_bf16 v[72:87], v[184:187], v[16:19], v[72:87]
    v_mfma_f32_32x32x16_bf16 v[104:119], v[188:191], v[16:19], v[104:119]
    s_waitcnt vmcnt(11)
    v_mfma_f32_32x32x16_bf16 v[56:71], v[192:195], v[20:23], v[56:71]
    v_mfma_f32_32x32x16_bf16 v[88:103], v[196:199], v[20:23], v[88:103]
    s_waitcnt vmcnt(10)
    v_mfma_f32_32x32x16_bf16 v[72:87], v[192:195], v[24:27], v[72:87]
    v_mfma_f32_32x32x16_bf16 v[104:119], v[196:199], v[24:27], v[104:119]
    s_waitcnt vmcnt(9)
    v_mfma_f32_32x32x16_bf16 v[56:71], v[200:203], v[28:31], v[56:71]
    v_mfma_f32_32x32x16_bf16 v[88:103], v[204:207], v[28:31], v[88:103]
    s_waitcnt vmcnt(8)
    v_mfma_f32_32x32x16_bf16 v[72:87], v[200:203], v[32:35], v[72:87]
    v_mfma_f32_32x32x16_bf16 v[104:119], v[204:207], v[32:35], v[104:119]
    s_waitcnt vmcnt(7)
    v_mfma_f32_32x32x16_bf16 v[56:71], v[208:211], v[36:39], v[56:71]
    v_mfma_f32_32x32x16_bf16 v[88:103], v[212:215], v[36:39], v[88:103]
    s_waitcnt vmcnt(6)
    v_mfma_f32_32x32x16_bf16 v[72:87], v[208:211], v[40:43], v[72:87]
    v_mfma_f32_32x32x16_bf16 v[104:119], v[212:215], v[40:43], v[104:119]
    s_waitcnt vmcnt(5)
    v_mfma_f32_32x32x16_bf16 v[56:71], v[216:219], v[44:47], v[56:71]
    v_mfma_f32_32x32x16_bf16 v[88:103], v[220:223], v[44:47], v[88:103]
    s_waitcnt vmcnt(4)
    v_mfma_f32_32x32x16_bf16 v[72:87], v[216:219], v[48:51], v[72:87]
    v_mfma_f32_32x32x16_bf16 v[104:119], v[220:223], v[48:51], v[104:119]
    s_waitcnt vmcnt(3)
    v_mfma_f32_32x32x16_bf16 v[56:71], v[224:227], v[52:55], v[56:71]
    v_mfma_f32_32x32x16_bf16 v[88:103], v[228:231], v[52:55], v[88:103]
    s_waitcnt vmcnt(2)
    v_mfma_f32_32x32x16_bf16 v[72:87], v[224:227], v[240:243], v[72:87]
    v_mfma_f32_32x32x16_bf16 v[104:119], v[228:231], v[240:243], v[104:119]
    s_waitcnt vmcnt(1)
    v_mfma_f32_32x32x16_bf16 v[56:71], v[232:235], v[244:247], v[56:71]
    v_mfma_f32_32x32x16_bf16 v[88:103], v[236:239], v[244:247], v[88:103]
    s_waitcnt vmcnt(0)
    v_mfma_f32_32x32x16_bf16 v[72:87], v[232:235], v[248:251], v[72:87]
    v_mfma_f32_32x32x16_bf16 v[104:119], v[236:239], v[248:251], v[104:119]
    s_lshl_b32 s48, s22, 14
    v_add_u32 v2, s48, v1
    s_lshl_b32 s48, s22, 11
    v_add_u32 v3, s48, v1
    v_add_u32 v4, 65536, v3
    s_nop 7
    ds_write_b128 v2, v[56:59] offset:0
    ds_write_b128 v2, v[60:63] offset:1024
    ds_write_b128 v2, v[64:67] offset:2048
    ds_write_b128 v2, v[68:71] offset:3072
    ds_write_b128 v2, v[72:75] offset:4096
    ds_write_b128 v2, v[76:79] offset:5120
    ds_write_b128 v2, v[80:83] offset:6144
    ds_write_b128 v2, v[84:87] offset:7168
    ds_write_b128 v2, v[88:91] offset:8192
    ds_write_b128 v2, v[92:95] offset:9216
    ds_write_b128 v2, v[96:99] offset:10240
    ds_write_b128 v2, v[100:103] offset:11264
    ds_write_b128 v2, v[104:107] offset:12288
    ds_write_b128 v2, v[108:111] offset:13312
    ds_write_b128 v2, v[112:115] offset:14336
    ds_write_b128 v2, v[116:119] offset:15360
    v_lshlrev_b32 v12, 16, v8
    v_and_b32 v13, 0xffff0000, v8
    v_lshlrev_b32 v14, 16, v9
    v_and_b32 v15, 0xffff0000, v9
    v_lshlrev_b32 v16, 16, v10
    v_and_b32 v17, 0xffff0000, v10
    v_lshlrev_b32 v18, 16, v11
    v_and_b32 v19, 0xffff0000, v11
    v_lshrrev_b32 v6, 4, v1
    v_and_b32 v7, 31, v6
    v_lshlrev_b32 v7, 10, v7
    v_lshrrev_b32 v6, 5, v6
    v_lshl_add_u32 v7, v6, 4, v7
    s_waitcnt lgkmcnt(0)
    s_barrier
    ds_read_b128 v[56:59], v3 offset:0
    ds_read_b128 v[60:63], v3 offset:1024
    ds_read_b128 v[64:67], v3 offset:16384
    ds_read_b128 v[68:71], v3 offset:17408
    ds_read_b128 v[72:75], v3 offset:32768
    ds_read_b128 v[76:79], v3 offset:33792
    ds_read_b128 v[80:83], v3 offset:49152
    ds_read_b128 v[84:87], v3 offset:50176
    ds_read_b128 v[88:91], v4 offset:0
    ds_read_b128 v[92:95], v4 offset:1024
    ds_read_b128 v[96:99], v4 offset:16384
    ds_read_b128 v[100:103], v4 offset:17408
    ds_read_b128 v[104:107], v4 offset:32768
    ds_read_b128 v[108:111], v4 offset:33792
    ds_read_b128 v[112:115], v4 offset:49152
    ds_read_b128 v[116:119], v4 offset:50176
    s_waitcnt lgkmcnt(12)
    v_add_f32 v56, v56, v64
    v_add_f32 v57, v57, v65
    v_add_f32 v58, v58, v66
    v_add_f32 v59, v59, v67
    v_add_f32 v60, v60, v68
    v_add_f32 v61, v61, v69
    v_add_f32 v62, v62, v70
    v_add_f32 v63, v63, v71
    s_waitcnt lgkmcnt(10)
    v_add_f32 v56, v56, v72
    v_add_f32 v57, v57, v73
    v_add_f32 v58, v58, v74
    v_add_f32 v59, v59, v75
    v_add_f32 v60, v60, v76
    v_add_f32 v61, v61, v77
    v_add_f32 v62, v62, v78
    v_add_f32 v63, v63, v79
    s_waitcnt lgkmcnt(8)
    v_add_f32 v56, v56, v80
    v_add_f32 v57, v57, v81
    v_add_f32 v58, v58, v82
    v_add_f32 v59, v59, v83
    v_add_f32 v60, v60, v84
    v_add_f32 v61, v61, v85
    v_add_f32 v62, v62, v86
    v_add_f32 v63, v63, v87
    s_waitcnt lgkmcnt(6)
    v_add_f32 v56, v56, v88
    v_add_f32 v57, v57, v89
    v_add_f32 v58, v58, v90
    v_add_f32 v59, v59, v91
    v_add_f32 v60, v60, v92
    v_add_f32 v61, v61, v93
    v_add_f32 v62, v62, v94
    v_add_f32 v63, v63, v95
    s_waitcnt lgkmcnt(4)
    v_add_f32 v56, v56, v96
    v_add_f32 v57, v57, v97
    v_add_f32 v58, v58, v98
    v_add_f32 v59, v59, v99
    v_add_f32 v60, v60, v100
    v_add_f32 v61, v61, v101
    v_add_f32 v62, v62, v102
    v_add_f32 v63, v63, v103
    s_waitcnt lgkmcnt(2)
    v_add_f32 v56, v56, v104
    v_add_f32 v57, v57, v105
    v_add_f32 v58, v58, v106
    v_add_f32 v59, v59, v107
    v_add_f32 v60, v60, v108
    v_add_f32 v61, v61, v109
    v_add_f32 v62, v62, v110
    v_add_f32 v63, v63, v111
    s_waitcnt lgkmcnt(0)
    v_add_f32 v56, v56, v112
    v_add_f32 v57, v57, v113
    v_add_f32 v58, v58, v114
    v_add_f32 v59, v59, v115
    v_add_f32 v60, v60, v116
    v_add_f32 v61, v61, v117
    v_add_f32 v62, v62, v118
    v_add_f32 v63, v63, v119
    v_fma_f32 v12, v56, v122, v12
    v_fma_f32 v13, v57, v122, v13
    v_fma_f32 v14, v58, v122, v14
    v_fma_f32 v15, v59, v122, v15
    v_fma_f32 v16, v60, v122, v16
    v_fma_f32 v17, v61, v122, v17
    v_fma_f32 v18, v62, v122, v18
    v_fma_f32 v19, v63, v122, v19
    v_cvt_pk_bf16_f32 v20, v12, v13
    v_cvt_pk_bf16_f32 v21, v14, v15
    v_cvt_pk_bf16_f32 v22, v16, v17
    v_cvt_pk_bf16_f32 v23, v18, v19
    s_nop 1
    v_permlane32_swap_b32 v20, v22
    v_permlane32_swap_b32 v21, v23
    buffer_store_dwordx4 v[20:23], v7, s[32:35], s17 offen
L_end:
    s_endpgm
.section .rodata,"a"
.p2align 6
.amdhsa_kernel sequential_preLN__mha_block__dense_activation_relu__prompt_kernel
  .amdhsa_next_free_vgpr 256
  .amdhsa_next_free_sgpr 74
  .amdhsa_accum_offset 256
  .amdhsa_group_segment_fixed_size 0
  .amdhsa_kernarg_size 72
  .amdhsa_user_sgpr_count 2
  .amdhsa_user_sgpr_kernarg_segment_ptr 1
  .amdhsa_system_sgpr_workgroup_id_x 1
.end_amdhsa_kernel
```
